```python
import torch

def _softmax(x, axis=-1):
    return torch.softmax(x, dim=axis)
def _gelu(x):
    return torch.nn.functional.gelu(x, approximate="tanh")
def _silu(x):
    return torch.nn.functional.silu(x)
def _sigmoid(x):
    return torch.sigmoid(x)
def _layernorm(x, axis=-1, eps=1e-5):
    m = x.mean(dim=axis, keepdim=True)
    v = x.var(dim=axis, keepdim=True, unbiased=False)
    return (x - m) / torch.sqrt(v + eps)
def _scatter_add(tgt, idx, src, axis=0):
    return tgt.clone().index_add_(axis, idx, src)
def _segment_sum(src, seg, n):
    out = torch.zeros((n,) + src.shape[1:], dtype=src.dtype)
    return out.index_add_(0, seg, src)
def _pad(x, pw):
    flat = tuple(v for pair in reversed(pw) for v in pair)
    return torch.nn.functional.pad(x, flat)

kernel_name = 'parallel_sum__mha_block__swiglu_ffn__prompt'

def setup_inputs():

    _w = (lambda a: (lambda t: t.to(torch.bfloat16) if t.is_floating_point() else t)(torch.as_tensor(a)))
    def _A_setup():
        B, S, D, H = 1, 2048, 512, 32
        return {
            "x": _w((lambda *s: torch.randn(*s, dtype=torch.bfloat16) * 0.05)(B, S, D)),
            "wqkv": _w((lambda *s: torch.randn(*s, dtype=torch.bfloat16) * 0.2)(D, 3 * D)),
            "wo": _w((lambda *s: torch.randn(*s, dtype=torch.bfloat16) * 0.1)(D, D)),
        }
    _A_in = _A_setup()

    def _B_setup():
        B, S, D, F = 1, 2048, 512, 1376
        return {
            "x": _w((lambda *s: torch.randn(*s, dtype=torch.bfloat16) * 0.05)(B, S, D)),
            "w_gate": _w((lambda *s: torch.randn(*s, dtype=torch.bfloat16) * 0.1)(D, F)),
            "w_up": _w((lambda *s: torch.randn(*s, dtype=torch.bfloat16) * 0.1)(D, F)),
            "w_down": _w((lambda *s: torch.randn(*s, dtype=torch.bfloat16) * 0.1)(F, D)),
        }
    _B_in = _B_setup()

    return {
        "A_x": _A_in["x"],
        "A_wqkv": _A_in["wqkv"],
        "A_wo": _A_in["wo"],
        "B_x": _B_in["x"],
        "B_w_gate": _B_in["w_gate"],
        "B_w_up": _B_in["w_up"],
        "B_w_down": _B_in["w_down"],
    }

def reference(A_x, A_wqkv, A_wo, B_x, B_w_gate, B_w_up, B_w_down):
    def _A_ref(x, wqkv, wo):
        B, S, D = x.shape
        H = 32
        Dh = D // H
        qkv = (lambda x, *d: x.permute(*d))((x @ wqkv).reshape(B, S, 3, H, Dh), 2, 0, 3, 1, 4)
        q, k, v = qkv[0], qkv[1], qkv[2]
        scores = torch.einsum("bhqd,bhkd->bhqk", q, k) * (Dh ** -0.5)
        p = _softmax(scores, axis=-1)
        o = torch.einsum("bhqk,bhkd->bhqd", p, v)
        return (lambda x, *d: x.permute(*d))(o, 0, 2, 1, 3).reshape(B, S, D) @ wo

    def _B_ref(x, w_gate, w_up, w_down):
        g = _silu(x @ w_gate)
        u = x @ w_up
        return (g * u) @ w_down

    x = A_x
    xn = _layernorm(x, axis=-1)
    return x + _A_ref(xn, A_wqkv, A_wo) + _B_ref(xn, B_w_gate, B_w_up, B_w_down)
```

```asm
; @launch kernel=k0_kernel grid=(128,1,1) block=(256,1,1) lds=0
; @launch kernel=k1_kernel grid=(256,1,1) block=(576,1,1) lds=114688
; @launch kernel=k2_kernel grid=(256,1,1) block=(768,1,1) lds=157696
; @launch kernel=k3_kernel grid=(256,1,1) block=(256,1,1) lds=132096
.amdgcn_target "amdgcn-amd-amdhsa--gfx950"
.text
.globl k0_kernel
.p2align 8
.type k0_kernel,@function
k0_kernel:
  s_cmp_ge_u32 s2, 128
  s_cbranch_scc1 K0_END
  s_load_dwordx2 s[4:5], s[0:1], 0
  s_load_dwordx2 s[12:13], s[0:1], 72
  v_lshrrev_b32 v1, 6, v0
  s_nop 0
  v_readfirstlane_b32 s16, v1
  v_and_b32 v2, 63, v0
  s_waitcnt lgkmcnt(0)
  s_mov_b32 s20, s4
  s_and_b32 s21, s5, 0xffff
  s_mov_b32 s22, 2097152
  s_mov_b32 s23, 0x20000
  s_mov_b32 s24, s12
  s_and_b32 s25, s13, 0xffff
  s_mov_b32 s26, 268435456
  s_mov_b32 s27, 0x20000
  v_lshrrev_b32 v3, 4, v2
  v_and_b32 v4, 15, v2
  s_lshl_b32 s17, s2, 4
  s_lshl_b32 s18, s16, 2
  s_add_u32 s17, s17, s18
  v_add_u32 v5, s17, v3
  v_lshlrev_b32 v6, 10, v5
  v_lshl_add_u32 v6, v4, 4, v6
  buffer_load_dwordx4 v[8:11], v6, s[20:23], 0 offen offset:0
  buffer_load_dwordx4 v[12:15], v6, s[20:23], 0 offen offset:256
  buffer_load_dwordx4 v[16:19], v6, s[20:23], 0 offen offset:512
  buffer_load_dwordx4 v[20:23], v6, s[20:23], 0 offen offset:768
  s_load_dwordx2 s[6:7], s[0:1], 8
  s_load_dwordx4 s[8:11], s[0:1], 32
  s_and_b32 s30, s2, 7
  s_lshr_b32 s31, s2, 3
  s_lshl_b32 s31, s31, 2
  s_add_u32 s31, s31, s16
  v_lshrrev_b32 v75, 3, v2
  s_lshl_b32 s31, s31, 3
  v_add_u32 v75, s31, v75
  v_and_b32 v76, 7, v2
  s_waitcnt lgkmcnt(0)
  s_cmp_lt_u32 s30, 3
  s_cbranch_scc0 K0_WF
  s_mov_b32 s32, s6
  s_and_b32 s33, s7, 0xffff
  s_mov_b32 s34, 1572864
  s_mov_b32 s35, 0x20000
  v_mul_u32_u24 v77, 3072, v75
  v_lshl_add_u32 v77, v76, 7, v77
  s_lshl_b32 s31, s30, 10
  buffer_load_dword v78, v77, s[32:35], s31 offen
  buffer_load_dword v78, v77, s[32:35], s31 offen
  s_branch K0_WD
K0_WF:
  s_mov_b32 s32, s8
  s_and_b32 s33, s9, 0xffff
  s_mov_b32 s34, 1409024
  s_mov_b32 s35, 0x20000
  s_mov_b32 s36, s10
  s_and_b32 s37, s11, 0xffff
  s_mov_b32 s38, 1409024
  s_mov_b32 s39, 0x20000
  v_mul_u32_u24 v77, 2752, v75
  v_and_b32 v79, 3, v76
  v_lshl_add_u32 v77, v79, 7, v77
  s_sub_u32 s31, s30, 3
  s_lshl_b32 s31, s31, 9
  v_cmp_gt_u32 vcc, 4, v76
  s_nop 3
  s_and_saveexec_b64 s[40:41], vcc
  buffer_load_dword v78, v77, s[32:35], s31 offen
  s_andn2_b64 exec, s[40:41], exec
  buffer_load_dword v78, v77, s[36:39], s31 offen
  s_mov_b64 exec, s[40:41]
K0_WD:
  s_mov_b32 s32, s8
  s_and_b32 s33, s9, 0xffff
  s_mov_b32 s34, 1409024
  s_mov_b32 s35, 0x20000
  s_mov_b32 s36, s10
  s_and_b32 s37, s11, 0xffff
  s_mov_b32 s38, 1409024
  s_mov_b32 s39, 0x20000
  v_and_b32 v79, 7, v2
  s_lshr_b32 s31, s2, 3
  s_lshl_b32 s31, s31, 2
  s_add_u32 s31, s31, s16
  s_lshl_b32 s31, s31, 3
  v_add_u32 v79, s31, v79
  v_mul_u32_u24 v77, 2752, v79
  v_bfe_u32 v79, v2, 3, 1
  v_lshl_add_u32 v77, v79, 7, v77
  v_add_u32 v77, 2560, v77
  buffer_load_dword v78, v77, s[32:35], 0 offen
  buffer_load_dword v78, v77, s[36:39], 0 offen
  v_lshrrev_b32 v7, 5, v5
  v_lshlrev_b32 v7, 15, v7
  v_lshrrev_b32 v66, 1, v4
  v_lshl_add_u32 v7, v66, 10, v7
  v_and_b32 v66, 1, v4
  v_lshl_add_u32 v7, v66, 9, v7
  v_and_b32 v66, 31, v5
  v_lshl_add_u32 v7, v66, 4, v7
  s_waitcnt vmcnt(4)
  v_lshlrev_b32 v32, 16, v8
  v_and_b32 v33, 0xffff0000, v8
  v_lshlrev_b32 v34, 16, v9
  v_and_b32 v35, 0xffff0000, v9
  v_lshlrev_b32 v36, 16, v10
  v_and_b32 v37, 0xffff0000, v10
  v_lshlrev_b32 v38, 16, v11
  v_and_b32 v39, 0xffff0000, v11
  v_lshlrev_b32 v40, 16, v12
  v_and_b32 v41, 0xffff0000, v12
  v_lshlrev_b32 v42, 16, v13
  v_and_b32 v43, 0xffff0000, v13
  v_lshlrev_b32 v44, 16, v14
  v_and_b32 v45, 0xffff0000, v14
  v_lshlrev_b32 v46, 16, v15
  v_and_b32 v47, 0xffff0000, v15
  v_lshlrev_b32 v48, 16, v16
  v_and_b32 v49, 0xffff0000, v16
  v_lshlrev_b32 v50, 16, v17
  v_and_b32 v51, 0xffff0000, v17
  v_lshlrev_b32 v52, 16, v18
  v_and_b32 v53, 0xffff0000, v18
  v_lshlrev_b32 v54, 16, v19
  v_and_b32 v55, 0xffff0000, v19
  v_lshlrev_b32 v56, 16, v20
  v_and_b32 v57, 0xffff0000, v20
  v_lshlrev_b32 v58, 16, v21
  v_and_b32 v59, 0xffff0000, v21
  v_lshlrev_b32 v60, 16, v22
  v_and_b32 v61, 0xffff0000, v22
  v_lshlrev_b32 v62, 16, v23
  v_and_b32 v63, 0xffff0000, v23
  v_add_f32 v67, v32, v33
  v_add_f32 v68, v34, v35
  v_add_f32 v67, v67, v36
  v_add_f32 v68, v68, v37
  v_add_f32 v67, v67, v38
  v_add_f32 v68, v68, v39
  v_add_f32 v67, v67, v40
  v_add_f32 v68, v68, v41
  v_add_f32 v67, v67, v42
  v_add_f32 v68, v68, v43
  v_add_f32 v67, v67, v44
  v_add_f32 v68, v68, v45
  v_add_f32 v67, v67, v46
  v_add_f32 v68, v68, v47
  v_add_f32 v67, v67, v48
  v_add_f32 v68, v68, v49
  v_add_f32 v67, v67, v50
  v_add_f32 v68, v68, v51
  v_add_f32 v67, v67, v52
  v_add_f32 v68, v68, v53
  v_add_f32 v67, v67, v54
  v_add_f32 v68, v68, v55
  v_add_f32 v67, v67, v56
  v_add_f32 v68, v68, v57
  v_add_f32 v67, v67, v58
  v_add_f32 v68, v68, v59
  v_add_f32 v67, v67, v60
  v_add_f32 v68, v68, v61
  v_add_f32 v67, v67, v62
  v_add_f32 v68, v68, v63
  v_add_f32 v67, v67, v68
  s_nop 1
  v_add_f32_dpp v68, v67, v67 quad_perm:[1,0,3,2] row_mask:0xf bank_mask:0xf
  v_mov_b32 v67, v68
  s_nop 1
  v_add_f32_dpp v68, v67, v67 quad_perm:[2,3,0,1] row_mask:0xf bank_mask:0xf
  v_mov_b32 v67, v68
  s_nop 1
  v_add_f32_dpp v68, v67, v67 row_half_mirror row_mask:0xf bank_mask:0xf
  v_mov_b32 v67, v68
  s_nop 1
  v_add_f32_dpp v68, v67, v67 row_mirror row_mask:0xf bank_mask:0xf
  v_mov_b32 v67, v68
  v_mul_f32 v67, 0x3b000000, v67
  v_sub_f32 v69, v32, v67
  v_mul_f32 v70, v69, v69
  v_sub_f32 v71, v33, v67
  v_mul_f32 v72, v71, v71
  v_sub_f32 v69, v34, v67
  v_fmac_f32 v70, v69, v69
  v_sub_f32 v71, v35, v67
  v_fmac_f32 v72, v71, v71
  v_sub_f32 v69, v36, v67
  v_fmac_f32 v70, v69, v69
  v_sub_f32 v71, v37, v67
  v_fmac_f32 v72, v71, v71
  v_sub_f32 v69, v38, v67
  v_fmac_f32 v70, v69, v69
  v_sub_f32 v71, v39, v67
  v_fmac_f32 v72, v71, v71
  v_sub_f32 v69, v40, v67
  v_fmac_f32 v70, v69, v69
  v_sub_f32 v71, v41, v67
  v_fmac_f32 v72, v71, v71
  v_sub_f32 v69, v42, v67
  v_fmac_f32 v70, v69, v69
  v_sub_f32 v71, v43, v67
  v_fmac_f32 v72, v71, v71
  v_sub_f32 v69, v44, v67
  v_fmac_f32 v70, v69, v69
  v_sub_f32 v71, v45, v67
  v_fmac_f32 v72, v71, v71
  v_sub_f32 v69, v46, v67
  v_fmac_f32 v70, v69, v69
  v_sub_f32 v71, v47, v67
  v_fmac_f32 v72, v71, v71
  v_sub_f32 v69, v48, v67
  v_fmac_f32 v70, v69, v69
  v_sub_f32 v71, v49, v67
  v_fmac_f32 v72, v71, v71
  v_sub_f32 v69, v50, v67
  v_fmac_f32 v70, v69, v69
  v_sub_f32 v71, v51, v67
  v_fmac_f32 v72, v71, v71
  v_sub_f32 v69, v52, v67
  v_fmac_f32 v70, v69, v69
  v_sub_f32 v71, v53, v67
  v_fmac_f32 v72, v71, v71
  v_sub_f32 v69, v54, v67
  v_fmac_f32 v70, v69, v69
  v_sub_f32 v71, v55, v67
  v_fmac_f32 v72, v71, v71
  v_sub_f32 v69, v56, v67
  v_fmac_f32 v70, v69, v69
  v_sub_f32 v71, v57, v67
  v_fmac_f32 v72, v71, v71
  v_sub_f32 v69, v58, v67
  v_fmac_f32 v70, v69, v69
  v_sub_f32 v71, v59, v67
  v_fmac_f32 v72, v71, v71
  v_sub_f32 v69, v60, v67
  v_fmac_f32 v70, v69, v69
  v_sub_f32 v71, v61, v67
  v_fmac_f32 v72, v71, v71
  v_sub_f32 v69, v62, v67
  v_fmac_f32 v70, v69, v69
  v_sub_f32 v71, v63, v67
  v_fmac_f32 v72, v71, v71
  v_add_f32 v70, v70, v72
  s_nop 1
  v_add_f32_dpp v68, v70, v70 quad_perm:[1,0,3,2] row_mask:0xf bank_mask:0xf
  v_mov_b32 v70, v68
  s_nop 1
  v_add_f32_dpp v68, v70, v70 quad_perm:[2,3,0,1] row_mask:0xf bank_mask:0xf
  v_mov_b32 v70, v68
  s_nop 1
  v_add_f32_dpp v68, v70, v70 row_half_mirror row_mask:0xf bank_mask:0xf
  v_mov_b32 v70, v68
  s_nop 1
  v_add_f32_dpp v68, v70, v70 row_mirror row_mask:0xf bank_mask:0xf
  v_mov_b32 v70, v68
  v_mul_f32 v70, 0x3b000000, v70
  v_cvt_pk_bf16_f32 v67, v67, v67
  v_lshlrev_b32 v67, 16, v67
  v_cvt_pk_bf16_f32 v70, v70, v70
  v_lshlrev_b32 v70, 16, v70
  v_add_f32 v70, 0x3727c5ac, v70
  v_cvt_pk_bf16_f32 v70, v70, v70
  v_lshlrev_b32 v70, 16, v70
  v_sqrt_f32 v70, v70
  s_nop 0
  v_cvt_pk_bf16_f32 v70, v70, v70
  v_lshlrev_b32 v70, 16, v70
  v_rcp_f32 v71, v70
  v_sub_f32 v32, v32, v67
  v_sub_f32 v33, v33, v67
  v_cvt_pk_bf16_f32 v72, v32, v33
  v_lshlrev_b32 v32, 16, v72
  v_and_b32 v33, 0xffff0000, v72
  v_mul_f32 v73, v32, v71
  v_fma_f32 v74, -v73, v70, v32
  v_fma_f32 v32, v74, v71, v73
  v_mul_f32 v73, v33, v71
  v_fma_f32 v74, -v73, v70, v33
  v_fma_f32 v33, v74, v71, v73
  v_cvt_pk_bf16_f32 v8, v32, v33
  v_sub_f32 v34, v34, v67
  v_sub_f32 v35, v35, v67
  v_cvt_pk_bf16_f32 v72, v34, v35
  v_lshlrev_b32 v34, 16, v72
  v_and_b32 v35, 0xffff0000, v72
  v_mul_f32 v73, v34, v71
  v_fma_f32 v74, -v73, v70, v34
  v_fma_f32 v34, v74, v71, v73
  v_mul_f32 v73, v35, v71
  v_fma_f32 v74, -v73, v70, v35
  v_fma_f32 v35, v74, v71, v73
  v_cvt_pk_bf16_f32 v9, v34, v35
  v_sub_f32 v36, v36, v67
  v_sub_f32 v37, v37, v67
  v_cvt_pk_bf16_f32 v72, v36, v37
  v_lshlrev_b32 v36, 16, v72
  v_and_b32 v37, 0xffff0000, v72
  v_mul_f32 v73, v36, v71
  v_fma_f32 v74, -v73, v70, v36
  v_fma_f32 v36, v74, v71, v73
  v_mul_f32 v73, v37, v71
  v_fma_f32 v74, -v73, v70, v37
  v_fma_f32 v37, v74, v71, v73
  v_cvt_pk_bf16_f32 v10, v36, v37
  v_sub_f32 v38, v38, v67
  v_sub_f32 v39, v39, v67
  v_cvt_pk_bf16_f32 v72, v38, v39
  v_lshlrev_b32 v38, 16, v72
  v_and_b32 v39, 0xffff0000, v72
  v_mul_f32 v73, v38, v71
  v_fma_f32 v74, -v73, v70, v38
  v_fma_f32 v38, v74, v71, v73
  v_mul_f32 v73, v39, v71
  v_fma_f32 v74, -v73, v70, v39
  v_fma_f32 v39, v74, v71, v73
  v_cvt_pk_bf16_f32 v11, v38, v39
  v_sub_f32 v40, v40, v67
  v_sub_f32 v41, v41, v67
  v_cvt_pk_bf16_f32 v72, v40, v41
  v_lshlrev_b32 v40, 16, v72
  v_and_b32 v41, 0xffff0000, v72
  v_mul_f32 v73, v40, v71
  v_fma_f32 v74, -v73, v70, v40
  v_fma_f32 v40, v74, v71, v73
  v_mul_f32 v73, v41, v71
  v_fma_f32 v74, -v73, v70, v41
  v_fma_f32 v41, v74, v71, v73
  v_cvt_pk_bf16_f32 v12, v40, v41
  v_sub_f32 v42, v42, v67
  v_sub_f32 v43, v43, v67
  v_cvt_pk_bf16_f32 v72, v42, v43
  v_lshlrev_b32 v42, 16, v72
  v_and_b32 v43, 0xffff0000, v72
  v_mul_f32 v73, v42, v71
  v_fma_f32 v74, -v73, v70, v42
  v_fma_f32 v42, v74, v71, v73
  v_mul_f32 v73, v43, v71
  v_fma_f32 v74, -v73, v70, v43
  v_fma_f32 v43, v74, v71, v73
  v_cvt_pk_bf16_f32 v13, v42, v43
  v_sub_f32 v44, v44, v67
  v_sub_f32 v45, v45, v67
  v_cvt_pk_bf16_f32 v72, v44, v45
  v_lshlrev_b32 v44, 16, v72
  v_and_b32 v45, 0xffff0000, v72
  v_mul_f32 v73, v44, v71
  v_fma_f32 v74, -v73, v70, v44
  v_fma_f32 v44, v74, v71, v73
  v_mul_f32 v73, v45, v71
  v_fma_f32 v74, -v73, v70, v45
  v_fma_f32 v45, v74, v71, v73
  v_cvt_pk_bf16_f32 v14, v44, v45
  v_sub_f32 v46, v46, v67
  v_sub_f32 v47, v47, v67
  v_cvt_pk_bf16_f32 v72, v46, v47
  v_lshlrev_b32 v46, 16, v72
  v_and_b32 v47, 0xffff0000, v72
  v_mul_f32 v73, v46, v71
  v_fma_f32 v74, -v73, v70, v46
  v_fma_f32 v46, v74, v71, v73
  v_mul_f32 v73, v47, v71
  v_fma_f32 v74, -v73, v70, v47
  v_fma_f32 v47, v74, v71, v73
  v_cvt_pk_bf16_f32 v15, v46, v47
  v_sub_f32 v48, v48, v67
  v_sub_f32 v49, v49, v67
  v_cvt_pk_bf16_f32 v72, v48, v49
  v_lshlrev_b32 v48, 16, v72
  v_and_b32 v49, 0xffff0000, v72
  v_mul_f32 v73, v48, v71
  v_fma_f32 v74, -v73, v70, v48
  v_fma_f32 v48, v74, v71, v73
  v_mul_f32 v73, v49, v71
  v_fma_f32 v74, -v73, v70, v49
  v_fma_f32 v49, v74, v71, v73
  v_cvt_pk_bf16_f32 v16, v48, v49
  v_sub_f32 v50, v50, v67
  v_sub_f32 v51, v51, v67
  v_cvt_pk_bf16_f32 v72, v50, v51
  v_lshlrev_b32 v50, 16, v72
  v_and_b32 v51, 0xffff0000, v72
  v_mul_f32 v73, v50, v71
  v_fma_f32 v74, -v73, v70, v50
  v_fma_f32 v50, v74, v71, v73
  v_mul_f32 v73, v51, v71
  v_fma_f32 v74, -v73, v70, v51
  v_fma_f32 v51, v74, v71, v73
  v_cvt_pk_bf16_f32 v17, v50, v51
  v_sub_f32 v52, v52, v67
  v_sub_f32 v53, v53, v67
  v_cvt_pk_bf16_f32 v72, v52, v53
  v_lshlrev_b32 v52, 16, v72
  v_and_b32 v53, 0xffff0000, v72
  v_mul_f32 v73, v52, v71
  v_fma_f32 v74, -v73, v70, v52
  v_fma_f32 v52, v74, v71, v73
  v_mul_f32 v73, v53, v71
  v_fma_f32 v74, -v73, v70, v53
  v_fma_f32 v53, v74, v71, v73
  v_cvt_pk_bf16_f32 v18, v52, v53
  v_sub_f32 v54, v54, v67
  v_sub_f32 v55, v55, v67
  v_cvt_pk_bf16_f32 v72, v54, v55
  v_lshlrev_b32 v54, 16, v72
  v_and_b32 v55, 0xffff0000, v72
  v_mul_f32 v73, v54, v71
  v_fma_f32 v74, -v73, v70, v54
  v_fma_f32 v54, v74, v71, v73
  v_mul_f32 v73, v55, v71
  v_fma_f32 v74, -v73, v70, v55
  v_fma_f32 v55, v74, v71, v73
  v_cvt_pk_bf16_f32 v19, v54, v55
  v_sub_f32 v56, v56, v67
  v_sub_f32 v57, v57, v67
  v_cvt_pk_bf16_f32 v72, v56, v57
  v_lshlrev_b32 v56, 16, v72
  v_and_b32 v57, 0xffff0000, v72
  v_mul_f32 v73, v56, v71
  v_fma_f32 v74, -v73, v70, v56
  v_fma_f32 v56, v74, v71, v73
  v_mul_f32 v73, v57, v71
  v_fma_f32 v74, -v73, v70, v57
  v_fma_f32 v57, v74, v71, v73
  v_cvt_pk_bf16_f32 v20, v56, v57
  v_sub_f32 v58, v58, v67
  v_sub_f32 v59, v59, v67
  v_cvt_pk_bf16_f32 v72, v58, v59
  v_lshlrev_b32 v58, 16, v72
  v_and_b32 v59, 0xffff0000, v72
  v_mul_f32 v73, v58, v71
  v_fma_f32 v74, -v73, v70, v58
  v_fma_f32 v58, v74, v71, v73
  v_mul_f32 v73, v59, v71
  v_fma_f32 v74, -v73, v70, v59
  v_fma_f32 v59, v74, v71, v73
  v_cvt_pk_bf16_f32 v21, v58, v59
  v_sub_f32 v60, v60, v67
  v_sub_f32 v61, v61, v67
  v_cvt_pk_bf16_f32 v72, v60, v61
  v_lshlrev_b32 v60, 16, v72
  v_and_b32 v61, 0xffff0000, v72
  v_mul_f32 v73, v60, v71
  v_fma_f32 v74, -v73, v70, v60
  v_fma_f32 v60, v74, v71, v73
  v_mul_f32 v73, v61, v71
  v_fma_f32 v74, -v73, v70, v61
  v_fma_f32 v61, v74, v71, v73
  v_cvt_pk_bf16_f32 v22, v60, v61
  v_sub_f32 v62, v62, v67
  v_sub_f32 v63, v63, v67
  v_cvt_pk_bf16_f32 v72, v62, v63
  v_lshlrev_b32 v62, 16, v72
  v_and_b32 v63, 0xffff0000, v72
  v_mul_f32 v73, v62, v71
  v_fma_f32 v74, -v73, v70, v62
  v_fma_f32 v62, v74, v71, v73
  v_mul_f32 v73, v63, v71
  v_fma_f32 v74, -v73, v70, v63
  v_fma_f32 v63, v74, v71, v73
  v_cvt_pk_bf16_f32 v23, v62, v63
  s_mov_b32 s19, 33554432
  buffer_store_dwordx4 v[8:11], v7, s[24:27], s19 offen sc0 sc1
  s_mov_b32 s19, 33562624
  buffer_store_dwordx4 v[12:15], v7, s[24:27], s19 offen sc0 sc1
  s_mov_b32 s19, 33570816
  buffer_store_dwordx4 v[16:19], v7, s[24:27], s19 offen sc0 sc1
  s_mov_b32 s19, 33579008
  buffer_store_dwordx4 v[20:23], v7, s[24:27], s19 offen sc0 sc1
K0_END:
  s_endpgm
.globl k1_kernel
.p2align 8
.type k1_kernel,@function
k1_kernel:
  s_cmp_ge_u32 s2, 256
  s_cbranch_scc1 K1_END
  s_load_dwordx2 s[6:7], s[0:1], 8
  s_load_dwordx4 s[8:11], s[0:1], 32
  s_load_dwordx2 s[12:13], s[0:1], 72
  s_lshr_b32 s14, s2, 4
  s_and_b32 s15, s2, 7
  s_lshl_b32 s15, s15, 1
  s_bfe_u32 s17, s2, 0x10003
  s_add_u32 s15, s15, s17
  v_lshrrev_b32 v1, 6, v0
  s_nop 0
  v_readfirstlane_b32 s16, v1
  v_and_b32 v2, 63, v0
  s_waitcnt lgkmcnt(0)
  s_mov_b32 s24, s12
  s_and_b32 s25, s13, 0xffff
  s_mov_b32 s26, 268435456
  s_mov_b32 s27, 0x20000
  s_mov_b32 s48, s8
  s_and_b32 s49, s9, 0xffff
  s_mov_b32 s50, 1409024
  s_mov_b32 s51, 0x20000
  s_mov_b32 s52, s10
  s_and_b32 s53, s11, 0xffff
  s_mov_b32 s54, 1409024
  s_mov_b32 s55, 0x20000
  v_lshlrev_b32 v6, 4, v2
  v_and_b32 v3, 31, v2
  v_lshrrev_b32 v4, 5, v2
  v_and_b32 v5, 15, v2
  s_mov_b32 s46, 0xbfb8aa3b
  s_cmp_eq_u32 s16, 8
  s_cbranch_scc1 K1_MINI
  s_lshr_b32 s19, s16, 2
  s_and_b32 s21, s16, 3
  s_cmp_lt_u32 s15, 6
  s_cbranch_scc0 K1_FFN
  s_mov_b32 s28, s6
  s_and_b32 s29, s7, 0xffff
  s_mov_b32 s30, 1572864
  s_mov_b32 s31, 0x20000
  s_mov_b32 s36, 3072
  s_lshl_b32 s37, s15, 9
  s_lshl_b32 s38, s19, 8
  s_add_u32 s37, s37, s38
  s_branch K1_SEL
K1_FFN:
  s_cmp_eq_u32 s19, 0
  s_cselect_b32 s28, s48, s52
  s_cselect_b32 s29, s49, s53
  s_mov_b32 s30, 1409024
  s_mov_b32 s31, 0x20000
  s_mov_b32 s36, 2752
  s_sub_u32 s37, s15, 6
  s_lshl_b32 s37, s37, 8
K1_SEL:
  v_lshrrev_b32 v7, 4, v2
  v_bfe_u32 v8, v2, 2, 2
  v_xor_b32 v8, v8, v7
  v_lshlrev_b32 v8, 6, v8
  v_and_b32 v9, 3, v2
  v_lshl_add_u32 v8, v9, 4, v8
  s_lshl_b32 s38, s21, 2
  v_add_u32 v7, s38, v7
  v_mul_lo_u32 v12, v7, s36
  v_add_u32 v12, v12, v8
  v_add_u32 v12, s37, v12
  s_lshl_b32 s39, s36, 4
  s_lshl_b32 s18, s16, 10
  s_lshl_b32 s41, s14, 2
  s_add_u32 s41, s41, s21
  s_lshl_b32 s41, s41, 15
  s_lshl_b32 s42, s19, 10
  s_add_u32 s41, s41, s42
  s_add_u32 s41, s41, 33554432
  s_lshl_b32 s43, s21, 10
  s_add_u32 s43, s43, 8192
  s_mov_b32 s40, 0
  s_add_u32 m0, s18, 0
  s_nop 0
  buffer_load_dwordx4 v12, s[28:31], s40 offen lds
  s_add_u32 s40, s40, s39
  s_mul_i32 s44, s19, 14336
  s_add_u32 s44, s44, s43
  s_add_u32 m0, s44, 0
  s_nop 0
  buffer_load_dwordx4 v6, s[24:27], s41 offen lds
  s_add_u32 s41, s41, 2048
  s_add_u32 m0, s18, 14336
  s_nop 0
  buffer_load_dwordx4 v12, s[28:31], s40 offen lds
  s_add_u32 s40, s40, s39
  s_add_u32 m0, s18, 28672
  s_nop 0
  buffer_load_dwordx4 v12, s[28:31], s40 offen lds
  s_add_u32 s40, s40, s39
  s_mul_i32 s44, s19, 14336
  s_add_u32 s44, s44, s43
  s_add_u32 m0, s44, 28672
  s_nop 0
  buffer_load_dwordx4 v6, s[24:27], s41 offen lds
  s_add_u32 s41, s41, 2048
  s_add_u32 m0, s18, 43008
  s_nop 0
  buffer_load_dwordx4 v12, s[28:31], s40 offen lds
  s_add_u32 s40, s40, s39
  s_add_u32 m0, s18, 57344
  s_nop 0
  buffer_load_dwordx4 v12, s[28:31], s40 offen lds
  s_add_u32 s40, s40, s39
  s_mul_i32 s44, s19, 14336
  s_add_u32 s44, s44, s43
  s_add_u32 m0, s44, 57344
  s_nop 0
  buffer_load_dwordx4 v6, s[24:27], s41 offen lds
  s_add_u32 s41, s41, 2048
  s_add_u32 m0, s18, 71680
  s_nop 0
  buffer_load_dwordx4 v12, s[28:31], s40 offen lds
  s_add_u32 s40, s40, s39
  s_lshl_b32 s45, s19, 11
  s_add_u32 s45, s45, 8192
  v_add_u32 v10, s45, v6
  v_lshrrev_b32 v7, 2, v5
  v_lshl_add_u32 v11, v4, 3, v7
  v_lshlrev_b32 v11, 8, v11
  v_xor_b32 v7, s21, v7
  v_lshl_add_u32 v11, v7, 6, v11
  v_and_b32 v7, 3, v5
  v_lshl_add_u32 v11, v7, 3, v11
  v_bfe_u32 v7, v2, 4, 1
  v_lshl_add_u32 v11, v7, 5, v11
  v_add_u32 v13, 57344, v10
  v_add_u32 v14, 57344, v11
  v_mov_b32 v64, 0
  v_mov_b32 v65, 0
  v_mov_b32 v66, 0
  v_mov_b32 v67, 0
  v_mov_b32 v68, 0
  v_mov_b32 v69, 0
  v_mov_b32 v70, 0
  v_mov_b32 v71, 0
  v_mov_b32 v72, 0
  v_mov_b32 v73, 0
  v_mov_b32 v74, 0
  v_mov_b32 v75, 0
  v_mov_b32 v76, 0
  v_mov_b32 v77, 0
  v_mov_b32 v78, 0
  v_mov_b32 v79, 0
  v_mov_b32 v80, 0
  v_mov_b32 v81, 0
  v_mov_b32 v82, 0
  v_mov_b32 v83, 0
  v_mov_b32 v84, 0
  v_mov_b32 v85, 0
  v_mov_b32 v86, 0
  v_mov_b32 v87, 0
  v_mov_b32 v88, 0
  v_mov_b32 v89, 0
  v_mov_b32 v90, 0
  v_mov_b32 v91, 0
  v_mov_b32 v92, 0
  v_mov_b32 v93, 0
  v_mov_b32 v94, 0
  v_mov_b32 v95, 0
  v_mov_b32 v96, 0
  v_mov_b32 v97, 0
  v_mov_b32 v98, 0
  v_mov_b32 v99, 0
  v_mov_b32 v100, 0
  v_mov_b32 v101, 0
  v_mov_b32 v102, 0
  v_mov_b32 v103, 0
  v_mov_b32 v104, 0
  v_mov_b32 v105, 0
  v_mov_b32 v106, 0
  v_mov_b32 v107, 0
  v_mov_b32 v108, 0
  v_mov_b32 v109, 0
  v_mov_b32 v110, 0
  v_mov_b32 v111, 0
  v_mov_b32 v112, 0
  v_mov_b32 v113, 0
  v_mov_b32 v114, 0
  v_mov_b32 v115, 0
  v_mov_b32 v116, 0
  v_mov_b32 v117, 0
  v_mov_b32 v118, 0
  v_mov_b32 v119, 0
  v_mov_b32 v120, 0
  v_mov_b32 v121, 0
  v_mov_b32 v122, 0
  v_mov_b32 v123, 0
  v_mov_b32 v124, 0
  v_mov_b32 v125, 0
  v_mov_b32 v126, 0
  v_mov_b32 v127, 0
  s_waitcnt vmcnt(6)
  s_barrier
  s_lshl_b32 s42, s14, 2
  s_lshl_b32 s43, s19, 1
  s_add_u32 s42, s42, s43
  s_cmp_ge_u32 s15, 4
  s_cselect_b32 s58, 1, 0
  s_cmp_lt_u32 s15, 6
  s_cselect_b32 s59, 1, 0
  s_and_b32 s58, s58, s59
  s_lshl_b32 s43, s21, 10
  s_add_u32 s43, s43, 8192
  s_cmp_eq_u32 s58, 1
  s_cbranch_scc1 K1_VLOOP
  ds_read_b128 v[16:19], v10 offset:0
  ds_read_b128 v[20:23], v10 offset:1024
  ds_read_b64_tr_b16 v[24:25], v11 offset:0
  ds_read_b64_tr_b16 v[26:27], v11 offset:1024
  ds_read_b64_tr_b16 v[28:29], v11 offset:4096
  ds_read_b64_tr_b16 v[30:31], v11 offset:5120
  s_mov_b32 s47, 0
K1_LT:
  s_waitcnt lgkmcnt(0)
  ds_read_b128 v[32:35], v10 offset:14336
  ds_read_b128 v[36:39], v10 offset:15360
  ds_read_b64_tr_b16 v[40:41], v11 offset:14336
  ds_read_b64_tr_b16 v[42:43], v11 offset:15360
  ds_read_b64_tr_b16 v[44:45], v11 offset:18432
  ds_read_b64_tr_b16 v[46:47], v11 offset:19456
  v_mfma_f32_32x32x16_bf16 v[64:79], v[24:27], v[16:19], v[64:79]
  v_mfma_f32_32x32x16_bf16 v[80:95], v[28:31], v[16:19], v[80:95]
  v_mfma_f32_32x32x16_bf16 v[96:111], v[24:27], v[20:23], v[96:111]
  v_mfma_f32_32x32x16_bf16 v[112:127], v[28:31], v[20:23], v[112:127]
  s_waitcnt lgkmcnt(0)
  s_waitcnt vmcnt(3)
  s_barrier
  s_add_u32 m0, s18, 86016
  s_nop 0
  buffer_load_dwordx4 v12, s[28:31], s40 offen lds
  s_add_u32 s40, s40, s39
  s_mul_i32 s44, s19, 14336
  s_add_u32 s44, s44, s43
  s_add_u32 m0, s44, 86016
  s_nop 0
  buffer_load_dwordx4 v6, s[24:27], s41 offen lds
  s_add_u32 s41, s41, 2048
  s_add_u32 m0, s18, 100352
  s_nop 0
  buffer_load_dwordx4 v12, s[28:31], s40 offen lds
  s_add_u32 s40, s40, s39
  ds_read_b128 v[16:19], v10 offset:28672
  ds_read_b128 v[20:23], v10 offset:29696
  ds_read_b64_tr_b16 v[24:25], v11 offset:28672
  ds_read_b64_tr_b16 v[26:27], v11 offset:29696
  ds_read_b64_tr_b16 v[28:29], v11 offset:32768
  ds_read_b64_tr_b16 v[30:31], v11 offset:33792
  v_mfma_f32_32x32x16_bf16 v[64:79], v[40:43], v[32:35], v[64:79]
  v_mfma_f32_32x32x16_bf16 v[80:95], v[44:47], v[32:35], v[80:95]
  v_mfma_f32_32x32x16_bf16 v[96:111], v[40:43], v[36:39], v[96:111]
  v_mfma_f32_32x32x16_bf16 v[112:127], v[44:47], v[36:39], v[112:127]
  s_waitcnt lgkmcnt(0)
  ds_read_b128 v[32:35], v10 offset:43008
  ds_read_b128 v[36:39], v10 offset:44032
  ds_read_b64_tr_b16 v[40:41], v11 offset:43008
  ds_read_b64_tr_b16 v[42:43], v11 offset:44032
  ds_read_b64_tr_b16 v[44:45], v11 offset:47104
  ds_read_b64_tr_b16 v[46:47], v11 offset:48128
  v_mfma_f32_32x32x16_bf16 v[64:79], v[24:27], v[16:19], v[64:79]
  v_mfma_f32_32x32x16_bf16 v[80:95], v[28:31], v[16:19], v[80:95]
  v_mfma_f32_32x32x16_bf16 v[96:111], v[24:27], v[20:23], v[96:111]
  v_mfma_f32_32x32x16_bf16 v[112:127], v[28:31], v[20:23], v[112:127]
  s_waitcnt lgkmcnt(0)
  s_waitcnt vmcnt(3)
  s_barrier
  s_add_u32 m0, s18, 0
  s_nop 0
  buffer_load_dwordx4 v12, s[28:31], s40 offen lds
  s_add_u32 s40, s40, s39
  s_mul_i32 s44, s19, 14336
  s_add_u32 s44, s44, s43
  s_add_u32 m0, s44, 0
  s_nop 0
  buffer_load_dwordx4 v6, s[24:27], s41 offen lds
  s_add_u32 s41, s41, 2048
  s_add_u32 m0, s18, 14336
  s_nop 0
  buffer_load_dwordx4 v12, s[28:31], s40 offen lds
  s_add_u32 s40, s40, s39
  ds_read_b128 v[16:19], v13 offset:0
  ds_read_b128 v[20:23], v13 offset:1024
  ds_read_b64_tr_b16 v[24:25], v14 offset:0
  ds_read_b64_tr_b16 v[26:27], v14 offset:1024
  ds_read_b64_tr_b16 v[28:29], v14 offset:4096
  ds_read_b64_tr_b16 v[30:31], v14 offset:5120
  v_mfma_f32_32x32x16_bf16 v[64:79], v[40:43], v[32:35], v[64:79]
  v_mfma_f32_32x32x16_bf16 v[80:95], v[44:47], v[32:35], v[80:95]
  v_mfma_f32_32x32x16_bf16 v[96:111], v[40:43], v[36:39], v[96:111]
  v_mfma_f32_32x32x16_bf16 v[112:127], v[44:47], v[36:39], v[112:127]
  s_waitcnt lgkmcnt(0)
  ds_read_b128 v[32:35], v13 offset:14336
  ds_read_b128 v[36:39], v13 offset:15360
  ds_read_b64_tr_b16 v[40:41], v14 offset:14336
  ds_read_b64_tr_b16 v[42:43], v14 offset:15360
  ds_read_b64_tr_b16 v[44:45], v14 offset:18432
  ds_read_b64_tr_b16 v[46:47], v14 offset:19456
  v_mfma_f32_32x32x16_bf16 v[64:79], v[24:27], v[16:19], v[64:79]
  v_mfma_f32_32x32x16_bf16 v[80:95], v[28:31], v[16:19], v[80:95]
  v_mfma_f32_32x32x16_bf16 v[96:111], v[24:27], v[20:23], v[96:111]
  v_mfma_f32_32x32x16_bf16 v[112:127], v[28:31], v[20:23], v[112:127]
  s_waitcnt lgkmcnt(0)
  s_waitcnt vmcnt(3)
  s_barrier
  s_add_u32 m0, s18, 28672
  s_nop 0
  buffer_load_dwordx4 v12, s[28:31], s40 offen lds
  s_add_u32 s40, s40, s39
  s_mul_i32 s44, s19, 14336
  s_add_u32 s44, s44, s43
  s_add_u32 m0, s44, 28672
  s_nop 0
  buffer_load_dwordx4 v6, s[24:27], s41 offen lds
  s_add_u32 s41, s41, 2048
  s_add_u32 m0, s18, 43008
  s_nop 0
  buffer_load_dwordx4 v12, s[28:31], s40 offen lds
  s_add_u32 s40, s40, s39
  ds_read_b128 v[16:19], v13 offset:28672
  ds_read_b128 v[20:23], v13 offset:29696
  ds_read_b64_tr_b16 v[24:25], v14 offset:28672
  ds_read_b64_tr_b16 v[26:27], v14 offset:29696
  ds_read_b64_tr_b16 v[28:29], v14 offset:32768
  ds_read_b64_tr_b16 v[30:31], v14 offset:33792
  v_mfma_f32_32x32x16_bf16 v[64:79], v[40:43], v[32:35], v[64:79]
  v_mfma_f32_32x32x16_bf16 v[80:95], v[44:47], v[32:35], v[80:95]
  v_mfma_f32_32x32x16_bf16 v[96:111], v[40:43], v[36:39], v[96:111]
  v_mfma_f32_32x32x16_bf16 v[112:127], v[44:47], v[36:39], v[112:127]
  s_waitcnt lgkmcnt(0)
  ds_read_b128 v[32:35], v13 offset:43008
  ds_read_b128 v[36:39], v13 offset:44032
  ds_read_b64_tr_b16 v[40:41], v14 offset:43008
  ds_read_b64_tr_b16 v[42:43], v14 offset:44032
  ds_read_b64_tr_b16 v[44:45], v14 offset:47104
  ds_read_b64_tr_b16 v[46:47], v14 offset:48128
  v_mfma_f32_32x32x16_bf16 v[64:79], v[24:27], v[16:19], v[64:79]
  v_mfma_f32_32x32x16_bf16 v[80:95], v[28:31], v[16:19], v[80:95]
  v_mfma_f32_32x32x16_bf16 v[96:111], v[24:27], v[20:23], v[96:111]
  v_mfma_f32_32x32x16_bf16 v[112:127], v[28:31], v[20:23], v[112:127]
  s_waitcnt lgkmcnt(0)
  s_waitcnt vmcnt(3)
  s_barrier
  s_add_u32 m0, s18, 57344
  s_nop 0
  buffer_load_dwordx4 v12, s[28:31], s40 offen lds
  s_add_u32 s40, s40, s39
  s_mul_i32 s44, s19, 14336
  s_add_u32 s44, s44, s43
  s_add_u32 m0, s44, 57344
  s_nop 0
  buffer_load_dwordx4 v6, s[24:27], s41 offen lds
  s_add_u32 s41, s41, 2048
  s_add_u32 m0, s18, 71680
  s_nop 0
  buffer_load_dwordx4 v12, s[28:31], s40 offen lds
  s_add_u32 s40, s40, s39
  ds_read_b128 v[16:19], v10 offset:0
  ds_read_b128 v[20:23], v10 offset:1024
  ds_read_b64_tr_b16 v[24:25], v11 offset:0
  ds_read_b64_tr_b16 v[26:27], v11 offset:1024
  ds_read_b64_tr_b16 v[28:29], v11 offset:4096
  ds_read_b64_tr_b16 v[30:31], v11 offset:5120
  v_mfma_f32_32x32x16_bf16 v[64:79], v[40:43], v[32:35], v[64:79]
  v_mfma_f32_32x32x16_bf16 v[80:95], v[44:47], v[32:35], v[80:95]
  v_mfma_f32_32x32x16_bf16 v[96:111], v[40:43], v[36:39], v[96:111]
  v_mfma_f32_32x32x16_bf16 v[112:127], v[44:47], v[36:39], v[112:127]
  s_add_u32 s47, s47, 1
  s_cmp_lt_u32 s47, 4
  s_cbranch_scc1 K1_LT
  s_load_dwordx2 s[56:57], s[0:1], 48
  s_lshr_b32 s44, s2, 3
  s_lshl_b32 s44, s44, 3
  s_add_u32 s44, s44, s16
  s_mul_i32 s44, s44, 5504
  v_lshlrev_b32 v48, 7, v2
  v_cmp_gt_u32 vcc, 43, v2
  s_waitcnt lgkmcnt(0)
  s_mov_b32 s60, s56
  s_and_b32 s61, s57, 0xffff
  s_mov_b32 s62, 1409024
  s_mov_b32 s63, 0x20000
  s_and_saveexec_b64 s[56:57], vcc
  buffer_load_dword v49, v48, s[60:63], s44 offen
  s_mov_b64 exec, s[56:57]
  s_cmp_ge_u32 s15, 6
  s_cbranch_scc1 K1_EPI_H
  s_lshr_b32 s43, s15, 1
  s_lshl_b32 s43, s43, 21
  s_and_b32 s44, s15, 1
  s_lshl_b32 s44, s44, 20
  s_add_u32 s43, s43, s44
  s_lshl_b32 s44, s21, 17
  s_add_u32 s43, s43, s44
  s_lshl_b32 s44, s42, 10
  s_add_u32 s43, s43, s44
  v_add_u32 v9, s43, v6
  s_cmp_lt_u32 s15, 2
  s_cselect_b32 s44, 0x3eb8aa3b, 1.0
  v_mov_b32 v28, s44
  v_mul_f32 v64, v64, v28
  v_mul_f32 v65, v65, v28
  v_mul_f32 v66, v66, v28
  v_mul_f32 v67, v67, v28
  v_mul_f32 v68, v68, v28
  v_mul_f32 v69, v69, v28
  v_mul_f32 v70, v70, v28
  v_mul_f32 v71, v71, v28
  v_cvt_pk_bf16_f32 v16, v64, v65
  v_cvt_pk_bf16_f32 v17, v66, v67
  v_cvt_pk_bf16_f32 v18, v68, v69
  v_cvt_pk_bf16_f32 v19, v70, v71
  s_mov_b32 s45, 0
  buffer_store_dwordx4 v[16:19], v9, s[24:27], s45 offen sc0 sc1
  v_mul_f32 v72, v72, v28
  v_mul_f32 v73, v73, v28
  v_mul_f32 v74, v74, v28
  v_mul_f32 v75, v75, v28
  v_mul_f32 v76, v76, v28
  v_mul_f32 v77, v77, v28
  v_mul_f32 v78, v78, v28
  v_mul_f32 v79, v79, v28
  v_cvt_pk_bf16_f32 v16, v72, v73
  v_cvt_pk_bf16_f32 v17, v74, v75
  v_cvt_pk_bf16_f32 v18, v76, v77
  v_cvt_pk_bf16_f32 v19, v78, v79
  s_mov_b32 s45, 65536
  buffer_store_dwordx4 v[16:19], v9, s[24:27], s45 offen sc0 sc1
  v_mul_f32 v80, v80, v28
  v_mul_f32 v81, v81, v28
  v_mul_f32 v82, v82, v28
  v_mul_f32 v83, v83, v28
  v_mul_f32 v84, v84, v28
  v_mul_f32 v85, v85, v28
  v_mul_f32 v86, v86, v28
  v_mul_f32 v87, v87, v28
  v_cvt_pk_bf16_f32 v16, v80, v81
  v_cvt_pk_bf16_f32 v17, v82, v83
  v_cvt_pk_bf16_f32 v18, v84, v85
  v_cvt_pk_bf16_f32 v19, v86, v87
  s_mov_b32 s45, 524288
  buffer_store_dwordx4 v[16:19], v9, s[24:27], s45 offen sc0 sc1
  v_mul_f32 v88, v88, v28
  v_mul_f32 v89, v89, v28
  v_mul_f32 v90, v90, v28
  v_mul_f32 v91, v91, v28
  v_mul_f32 v92, v92, v28
  v_mul_f32 v93, v93, v28
  v_mul_f32 v94, v94, v28
  v_mul_f32 v95, v95, v28
  v_cvt_pk_bf16_f32 v16, v88, v89
  v_cvt_pk_bf16_f32 v17, v90, v91
  v_cvt_pk_bf16_f32 v18, v92, v93
  v_cvt_pk_bf16_f32 v19, v94, v95
  s_mov_b32 s45, 589824
  buffer_store_dwordx4 v[16:19], v9, s[24:27], s45 offen sc0 sc1
  v_mul_f32 v96, v96, v28
  v_mul_f32 v97, v97, v28
  v_mul_f32 v98, v98, v28
  v_mul_f32 v99, v99, v28
  v_mul_f32 v100, v100, v28
  v_mul_f32 v101, v101, v28
  v_mul_f32 v102, v102, v28
  v_mul_f32 v103, v103, v28
  v_cvt_pk_bf16_f32 v16, v96, v97
  v_cvt_pk_bf16_f32 v17, v98, v99
  v_cvt_pk_bf16_f32 v18, v100, v101
  v_cvt_pk_bf16_f32 v19, v102, v103
  s_mov_b32 s45, 1024
  buffer_store_dwordx4 v[16:19], v9, s[24:27], s45 offen sc0 sc1
  v_mul_f32 v104, v104, v28
  v_mul_f32 v105, v105, v28
  v_mul_f32 v106, v106, v28
  v_mul_f32 v107, v107, v28
  v_mul_f32 v108, v108, v28
  v_mul_f32 v109, v109, v28
  v_mul_f32 v110, v110, v28
  v_mul_f32 v111, v111, v28
  v_cvt_pk_bf16_f32 v16, v104, v105
  v_cvt_pk_bf16_f32 v17, v106, v107
  v_cvt_pk_bf16_f32 v18, v108, v109
  v_cvt_pk_bf16_f32 v19, v110, v111
  s_mov_b32 s45, 66560
  buffer_store_dwordx4 v[16:19], v9, s[24:27], s45 offen sc0 sc1
  v_mul_f32 v112, v112, v28
  v_mul_f32 v113, v113, v28
  v_mul_f32 v114, v114, v28
  v_mul_f32 v115, v115, v28
  v_mul_f32 v116, v116, v28
  v_mul_f32 v117, v117, v28
  v_mul_f32 v118, v118, v28
  v_mul_f32 v119, v119, v28
  v_cvt_pk_bf16_f32 v16, v112, v113
  v_cvt_pk_bf16_f32 v17, v114, v115
  v_cvt_pk_bf16_f32 v18, v116, v117
  v_cvt_pk_bf16_f32 v19, v118, v119
  s_mov_b32 s45, 525312
  buffer_store_dwordx4 v[16:19], v9, s[24:27], s45 offen sc0 sc1
  v_mul_f32 v120, v120, v28
  v_mul_f32 v121, v121, v28
  v_mul_f32 v122, v122, v28
  v_mul_f32 v123, v123, v28
  v_mul_f32 v124, v124, v28
  v_mul_f32 v125, v125, v28
  v_mul_f32 v126, v126, v28
  v_mul_f32 v127, v127, v28
  v_cvt_pk_bf16_f32 v16, v120, v121
  v_cvt_pk_bf16_f32 v17, v122, v123
  v_cvt_pk_bf16_f32 v18, v124, v125
  v_cvt_pk_bf16_f32 v19, v126, v127
  s_mov_b32 s45, 590848
  buffer_store_dwordx4 v[16:19], v9, s[24:27], s45 offen sc0 sc1
  s_branch K1_FIN
K1_EPI_H:
  s_sub_u32 s43, s15, 6
  s_lshl_b32 s43, s43, 2
  s_add_u32 s43, s43, s21
  s_mov_b32 s45, s42
  s_mul_i32 s45, s45, 88064
  s_lshl_b32 s43, s43, 11
  s_add_u32 s43, s43, s45
  s_add_u32 s43, s43, 6291456
  v_add_u32 v9, s43, v6
  v_cvt_pk_bf16_f32 v20, v64, v65
  v_cvt_pk_bf16_f32 v21, v80, v81
  v_lshlrev_b32 v22, 16, v20
  v_and_b32 v23, 0xffff0000, v20
  v_lshlrev_b32 v24, 16, v21
  v_and_b32 v25, 0xffff0000, v21
  v_mul_f32 v26, s46, v22
  v_exp_f32 v26, v26
  s_nop 0
  v_add_f32 v26, 1.0, v26
  v_rcp_f32 v26, v26
  s_nop 0
  v_mul_f32 v22, v22, v26
  v_mul_f32 v26, s46, v23
  v_exp_f32 v26, v26
  s_nop 0
  v_add_f32 v26, 1.0, v26
  v_rcp_f32 v26, v26
  s_nop 0
  v_mul_f32 v23, v23, v26
  v_cvt_pk_bf16_f32 v20, v22, v23
  v_lshlrev_b32 v22, 16, v20
  v_and_b32 v23, 0xffff0000, v20
  v_mul_f32 v22, v22, v24
  v_mul_f32 v23, v23, v25
  v_cvt_pk_bf16_f32 v16, v22, v23
  v_cvt_pk_bf16_f32 v20, v66, v67
  v_cvt_pk_bf16_f32 v21, v82, v83
  v_lshlrev_b32 v22, 16, v20
  v_and_b32 v23, 0xffff0000, v20
  v_lshlrev_b32 v24, 16, v21
  v_and_b32 v25, 0xffff0000, v21
  v_mul_f32 v26, s46, v22
  v_exp_f32 v26, v26
  s_nop 0
  v_add_f32 v26, 1.0, v26
  v_rcp_f32 v26, v26
  s_nop 0
  v_mul_f32 v22, v22, v26
  v_mul_f32 v26, s46, v23
  v_exp_f32 v26, v26
  s_nop 0
  v_add_f32 v26, 1.0, v26
  v_rcp_f32 v26, v26
  s_nop 0
  v_mul_f32 v23, v23, v26
  v_cvt_pk_bf16_f32 v20, v22, v23
  v_lshlrev_b32 v22, 16, v20
  v_and_b32 v23, 0xffff0000, v20
  v_mul_f32 v22, v22, v24
  v_mul_f32 v23, v23, v25
  v_cvt_pk_bf16_f32 v17, v22, v23
  v_cvt_pk_bf16_f32 v20, v68, v69
  v_cvt_pk_bf16_f32 v21, v84, v85
  v_lshlrev_b32 v22, 16, v20
  v_and_b32 v23, 0xffff0000, v20
  v_lshlrev_b32 v24, 16, v21
  v_and_b32 v25, 0xffff0000, v21
  v_mul_f32 v26, s46, v22
  v_exp_f32 v26, v26
  s_nop 0
  v_add_f32 v26, 1.0, v26
  v_rcp_f32 v26, v26
  s_nop 0
  v_mul_f32 v22, v22, v26
  v_mul_f32 v26, s46, v23
  v_exp_f32 v26, v26
  s_nop 0
  v_add_f32 v26, 1.0, v26
  v_rcp_f32 v26, v26
  s_nop 0
  v_mul_f32 v23, v23, v26
  v_cvt_pk_bf16_f32 v20, v22, v23
  v_lshlrev_b32 v22, 16, v20
  v_and_b32 v23, 0xffff0000, v20
  v_mul_f32 v22, v22, v24
  v_mul_f32 v23, v23, v25
  v_cvt_pk_bf16_f32 v18, v22, v23
  v_cvt_pk_bf16_f32 v20, v70, v71
  v_cvt_pk_bf16_f32 v21, v86, v87
  v_lshlrev_b32 v22, 16, v20
  v_and_b32 v23, 0xffff0000, v20
  v_lshlrev_b32 v24, 16, v21
  v_and_b32 v25, 0xffff0000, v21
  v_mul_f32 v26, s46, v22
  v_exp_f32 v26, v26
  s_nop 0
  v_add_f32 v26, 1.0, v26
  v_rcp_f32 v26, v26
  s_nop 0
  v_mul_f32 v22, v22, v26
  v_mul_f32 v26, s46, v23
  v_exp_f32 v26, v26
  s_nop 0
  v_add_f32 v26, 1.0, v26
  v_rcp_f32 v26, v26
  s_nop 0
  v_mul_f32 v23, v23, v26
  v_cvt_pk_bf16_f32 v20, v22, v23
  v_lshlrev_b32 v22, 16, v20
  v_and_b32 v23, 0xffff0000, v20
  v_mul_f32 v22, v22, v24
  v_mul_f32 v23, v23, v25
  v_cvt_pk_bf16_f32 v19, v22, v23
  s_mov_b32 s47, 0
  buffer_store_dwordx4 v[16:19], v9, s[24:27], s47 offen sc0 sc1
  v_cvt_pk_bf16_f32 v20, v72, v73
  v_cvt_pk_bf16_f32 v21, v88, v89
  v_lshlrev_b32 v22, 16, v20
  v_and_b32 v23, 0xffff0000, v20
  v_lshlrev_b32 v24, 16, v21
  v_and_b32 v25, 0xffff0000, v21
  v_mul_f32 v26, s46, v22
  v_exp_f32 v26, v26
  s_nop 0
  v_add_f32 v26, 1.0, v26
  v_rcp_f32 v26, v26
  s_nop 0
  v_mul_f32 v22, v22, v26
  v_mul_f32 v26, s46, v23
  v_exp_f32 v26, v26
  s_nop 0
  v_add_f32 v26, 1.0, v26
  v_rcp_f32 v26, v26
  s_nop 0
  v_mul_f32 v23, v23, v26
  v_cvt_pk_bf16_f32 v20, v22, v23
  v_lshlrev_b32 v22, 16, v20
  v_and_b32 v23, 0xffff0000, v20
  v_mul_f32 v22, v22, v24
  v_mul_f32 v23, v23, v25
  v_cvt_pk_bf16_f32 v16, v22, v23
  v_cvt_pk_bf16_f32 v20, v74, v75
  v_cvt_pk_bf16_f32 v21, v90, v91
  v_lshlrev_b32 v22, 16, v20
  v_and_b32 v23, 0xffff0000, v20
  v_lshlrev_b32 v24, 16, v21
  v_and_b32 v25, 0xffff0000, v21
  v_mul_f32 v26, s46, v22
  v_exp_f32 v26, v26
  s_nop 0
  v_add_f32 v26, 1.0, v26
  v_rcp_f32 v26, v26
  s_nop 0
  v_mul_f32 v22, v22, v26
  v_mul_f32 v26, s46, v23
  v_exp_f32 v26, v26
  s_nop 0
  v_add_f32 v26, 1.0, v26
  v_rcp_f32 v26, v26
  s_nop 0
  v_mul_f32 v23, v23, v26
  v_cvt_pk_bf16_f32 v20, v22, v23
  v_lshlrev_b32 v22, 16, v20
  v_and_b32 v23, 0xffff0000, v20
  v_mul_f32 v22, v22, v24
  v_mul_f32 v23, v23, v25
  v_cvt_pk_bf16_f32 v17, v22, v23
  v_cvt_pk_bf16_f32 v20, v76, v77
  v_cvt_pk_bf16_f32 v21, v92, v93
  v_lshlrev_b32 v22, 16, v20
  v_and_b32 v23, 0xffff0000, v20
  v_lshlrev_b32 v24, 16, v21
  v_and_b32 v25, 0xffff0000, v21
  v_mul_f32 v26, s46, v22
  v_exp_f32 v26, v26
  s_nop 0
  v_add_f32 v26, 1.0, v26
  v_rcp_f32 v26, v26
  s_nop 0
  v_mul_f32 v22, v22, v26
  v_mul_f32 v26, s46, v23
  v_exp_f32 v26, v26
  s_nop 0
  v_add_f32 v26, 1.0, v26
  v_rcp_f32 v26, v26
  s_nop 0
  v_mul_f32 v23, v23, v26
  v_cvt_pk_bf16_f32 v20, v22, v23
  v_lshlrev_b32 v22, 16, v20
  v_and_b32 v23, 0xffff0000, v20
  v_mul_f32 v22, v22, v24
  v_mul_f32 v23, v23, v25
  v_cvt_pk_bf16_f32 v18, v22, v23
  v_cvt_pk_bf16_f32 v20, v78, v79
  v_cvt_pk_bf16_f32 v21, v94, v95
  v_lshlrev_b32 v22, 16, v20
  v_and_b32 v23, 0xffff0000, v20
  v_lshlrev_b32 v24, 16, v21
  v_and_b32 v25, 0xffff0000, v21
  v_mul_f32 v26, s46, v22
  v_exp_f32 v26, v26
  s_nop 0
  v_add_f32 v26, 1.0, v26
  v_rcp_f32 v26, v26
  s_nop 0
  v_mul_f32 v22, v22, v26
  v_mul_f32 v26, s46, v23
  v_exp_f32 v26, v26
  s_nop 0
  v_add_f32 v26, 1.0, v26
  v_rcp_f32 v26, v26
  s_nop 0
  v_mul_f32 v23, v23, v26
  v_cvt_pk_bf16_f32 v20, v22, v23
  v_lshlrev_b32 v22, 16, v20
  v_and_b32 v23, 0xffff0000, v20
  v_mul_f32 v22, v22, v24
  v_mul_f32 v23, v23, v25
  v_cvt_pk_bf16_f32 v19, v22, v23
  s_mov_b32 s47, 1024
  buffer_store_dwordx4 v[16:19], v9, s[24:27], s47 offen sc0 sc1
  v_cvt_pk_bf16_f32 v20, v96, v97
  v_cvt_pk_bf16_f32 v21, v112, v113
  v_lshlrev_b32 v22, 16, v20
  v_and_b32 v23, 0xffff0000, v20
  v_lshlrev_b32 v24, 16, v21
  v_and_b32 v25, 0xffff0000, v21
  v_mul_f32 v26, s46, v22
  v_exp_f32 v26, v26
  s_nop 0
  v_add_f32 v26, 1.0, v26
  v_rcp_f32 v26, v26
  s_nop 0
  v_mul_f32 v22, v22, v26
  v_mul_f32 v26, s46, v23
  v_exp_f32 v26, v26
  s_nop 0
  v_add_f32 v26, 1.0, v26
  v_rcp_f32 v26, v26
  s_nop 0
  v_mul_f32 v23, v23, v26
  v_cvt_pk_bf16_f32 v20, v22, v23
  v_lshlrev_b32 v22, 16, v20
  v_and_b32 v23, 0xffff0000, v20
  v_mul_f32 v22, v22, v24
  v_mul_f32 v23, v23, v25
  v_cvt_pk_bf16_f32 v16, v22, v23
  v_cvt_pk_bf16_f32 v20, v98, v99
  v_cvt_pk_bf16_f32 v21, v114, v115
  v_lshlrev_b32 v22, 16, v20
  v_and_b32 v23, 0xffff0000, v20
  v_lshlrev_b32 v24, 16, v21
  v_and_b32 v25, 0xffff0000, v21
  v_mul_f32 v26, s46, v22
  v_exp_f32 v26, v26
  s_nop 0
  v_add_f32 v26, 1.0, v26
  v_rcp_f32 v26, v26
  s_nop 0
  v_mul_f32 v22, v22, v26
  v_mul_f32 v26, s46, v23
  v_exp_f32 v26, v26
  s_nop 0
  v_add_f32 v26, 1.0, v26
  v_rcp_f32 v26, v26
  s_nop 0
  v_mul_f32 v23, v23, v26
  v_cvt_pk_bf16_f32 v20, v22, v23
  v_lshlrev_b32 v22, 16, v20
  v_and_b32 v23, 0xffff0000, v20
  v_mul_f32 v22, v22, v24
  v_mul_f32 v23, v23, v25
  v_cvt_pk_bf16_f32 v17, v22, v23
  v_cvt_pk_bf16_f32 v20, v100, v101
  v_cvt_pk_bf16_f32 v21, v116, v117
  v_lshlrev_b32 v22, 16, v20
  v_and_b32 v23, 0xffff0000, v20
  v_lshlrev_b32 v24, 16, v21
  v_and_b32 v25, 0xffff0000, v21
  v_mul_f32 v26, s46, v22
  v_exp_f32 v26, v26
  s_nop 0
  v_add_f32 v26, 1.0, v26
  v_rcp_f32 v26, v26
  s_nop 0
  v_mul_f32 v22, v22, v26
  v_mul_f32 v26, s46, v23
  v_exp_f32 v26, v26
  s_nop 0
  v_add_f32 v26, 1.0, v26
  v_rcp_f32 v26, v26
  s_nop 0
  v_mul_f32 v23, v23, v26
  v_cvt_pk_bf16_f32 v20, v22, v23
  v_lshlrev_b32 v22, 16, v20
  v_and_b32 v23, 0xffff0000, v20
  v_mul_f32 v22, v22, v24
  v_mul_f32 v23, v23, v25
  v_cvt_pk_bf16_f32 v18, v22, v23
  v_cvt_pk_bf16_f32 v20, v102, v103
  v_cvt_pk_bf16_f32 v21, v118, v119
  v_lshlrev_b32 v22, 16, v20
  v_and_b32 v23, 0xffff0000, v20
  v_lshlrev_b32 v24, 16, v21
  v_and_b32 v25, 0xffff0000, v21
  v_mul_f32 v26, s46, v22
  v_exp_f32 v26, v26
  s_nop 0
  v_add_f32 v26, 1.0, v26
  v_rcp_f32 v26, v26
  s_nop 0
  v_mul_f32 v22, v22, v26
  v_mul_f32 v26, s46, v23
  v_exp_f32 v26, v26
  s_nop 0
  v_add_f32 v26, 1.0, v26
  v_rcp_f32 v26, v26
  s_nop 0
  v_mul_f32 v23, v23, v26
  v_cvt_pk_bf16_f32 v20, v22, v23
  v_lshlrev_b32 v22, 16, v20
  v_and_b32 v23, 0xffff0000, v20
  v_mul_f32 v22, v22, v24
  v_mul_f32 v23, v23, v25
  v_cvt_pk_bf16_f32 v19, v22, v23
  s_mov_b32 s47, 88064
  buffer_store_dwordx4 v[16:19], v9, s[24:27], s47 offen sc0 sc1
  v_cvt_pk_bf16_f32 v20, v104, v105
  v_cvt_pk_bf16_f32 v21, v120, v121
  v_lshlrev_b32 v22, 16, v20
  v_and_b32 v23, 0xffff0000, v20
  v_lshlrev_b32 v24, 16, v21
  v_and_b32 v25, 0xffff0000, v21
  v_mul_f32 v26, s46, v22
  v_exp_f32 v26, v26
  s_nop 0
  v_add_f32 v26, 1.0, v26
  v_rcp_f32 v26, v26
  s_nop 0
  v_mul_f32 v22, v22, v26
  v_mul_f32 v26, s46, v23
  v_exp_f32 v26, v26
  s_nop 0
  v_add_f32 v26, 1.0, v26
  v_rcp_f32 v26, v26
  s_nop 0
  v_mul_f32 v23, v23, v26
  v_cvt_pk_bf16_f32 v20, v22, v23
  v_lshlrev_b32 v22, 16, v20
  v_and_b32 v23, 0xffff0000, v20
  v_mul_f32 v22, v22, v24
  v_mul_f32 v23, v23, v25
  v_cvt_pk_bf16_f32 v16, v22, v23
  v_cvt_pk_bf16_f32 v20, v106, v107
  v_cvt_pk_bf16_f32 v21, v122, v123
  v_lshlrev_b32 v22, 16, v20
  v_and_b32 v23, 0xffff0000, v20
  v_lshlrev_b32 v24, 16, v21
  v_and_b32 v25, 0xffff0000, v21
  v_mul_f32 v26, s46, v22
  v_exp_f32 v26, v26
  s_nop 0
  v_add_f32 v26, 1.0, v26
  v_rcp_f32 v26, v26
  s_nop 0
  v_mul_f32 v22, v22, v26
  v_mul_f32 v26, s46, v23
  v_exp_f32 v26, v26
  s_nop 0
  v_add_f32 v26, 1.0, v26
  v_rcp_f32 v26, v26
  s_nop 0
  v_mul_f32 v23, v23, v26
  v_cvt_pk_bf16_f32 v20, v22, v23
  v_lshlrev_b32 v22, 16, v20
  v_and_b32 v23, 0xffff0000, v20
  v_mul_f32 v22, v22, v24
  v_mul_f32 v23, v23, v25
  v_cvt_pk_bf16_f32 v17, v22, v23
  v_cvt_pk_bf16_f32 v20, v108, v109
  v_cvt_pk_bf16_f32 v21, v124, v125
  v_lshlrev_b32 v22, 16, v20
  v_and_b32 v23, 0xffff0000, v20
  v_lshlrev_b32 v24, 16, v21
  v_and_b32 v25, 0xffff0000, v21
  v_mul_f32 v26, s46, v22
  v_exp_f32 v26, v26
  s_nop 0
  v_add_f32 v26, 1.0, v26
  v_rcp_f32 v26, v26
  s_nop 0
  v_mul_f32 v22, v22, v26
  v_mul_f32 v26, s46, v23
  v_exp_f32 v26, v26
  s_nop 0
  v_add_f32 v26, 1.0, v26
  v_rcp_f32 v26, v26
  s_nop 0
  v_mul_f32 v23, v23, v26
  v_cvt_pk_bf16_f32 v20, v22, v23
  v_lshlrev_b32 v22, 16, v20
  v_and_b32 v23, 0xffff0000, v20
  v_mul_f32 v22, v22, v24
  v_mul_f32 v23, v23, v25
  v_cvt_pk_bf16_f32 v18, v22, v23
  v_cvt_pk_bf16_f32 v20, v110, v111
  v_cvt_pk_bf16_f32 v21, v126, v127
  v_lshlrev_b32 v22, 16, v20
  v_and_b32 v23, 0xffff0000, v20
  v_lshlrev_b32 v24, 16, v21
  v_and_b32 v25, 0xffff0000, v21
  v_mul_f32 v26, s46, v22
  v_exp_f32 v26, v26
  s_nop 0
  v_add_f32 v26, 1.0, v26
  v_rcp_f32 v26, v26
  s_nop 0
  v_mul_f32 v22, v22, v26
  v_mul_f32 v26, s46, v23
  v_exp_f32 v26, v26
  s_nop 0
  v_add_f32 v26, 1.0, v26
  v_rcp_f32 v26, v26
  s_nop 0
  v_mul_f32 v23, v23, v26
  v_cvt_pk_bf16_f32 v20, v22, v23
  v_lshlrev_b32 v22, 16, v20
  v_and_b32 v23, 0xffff0000, v20
  v_mul_f32 v22, v22, v24
  v_mul_f32 v23, v23, v25
  v_cvt_pk_bf16_f32 v19, v22, v23
  s_mov_b32 s47, 89088
  buffer_store_dwordx4 v[16:19], v9, s[24:27], s47 offen sc0 sc1
  s_branch K1_FIN
K1_VLOOP:
  s_nop 0
  ds_read_b128 v[16:19], v10 offset:0
  ds_read_b128 v[20:23], v10 offset:1024
  ds_read_b64_tr_b16 v[24:25], v11 offset:0
  ds_read_b64_tr_b16 v[26:27], v11 offset:1024
  ds_read_b64_tr_b16 v[28:29], v11 offset:4096
  ds_read_b64_tr_b16 v[30:31], v11 offset:5120
  s_mov_b32 s47, 0
K1_LV:
  s_waitcnt lgkmcnt(0)
  ds_read_b128 v[32:35], v10 offset:14336
  ds_read_b128 v[36:39], v10 offset:15360
  ds_read_b64_tr_b16 v[40:41], v11 offset:14336
  ds_read_b64_tr_b16 v[42:43], v11 offset:15360
  ds_read_b64_tr_b16 v[44:45], v11 offset:18432
  ds_read_b64_tr_b16 v[46:47], v11 offset:19456
  v_mfma_f32_32x32x16_bf16 v[64:79], v[16:19], v[24:27], v[64:79]
  v_mfma_f32_32x32x16_bf16 v[80:95], v[16:19], v[28:31], v[80:95]
  v_mfma_f32_32x32x16_bf16 v[96:111], v[20:23], v[24:27], v[96:111]
  v_mfma_f32_32x32x16_bf16 v[112:127], v[20:23], v[28:31], v[112:127]
  s_waitcnt lgkmcnt(0)
  s_waitcnt vmcnt(3)
  s_barrier
  s_add_u32 m0, s18, 86016
  s_nop 0
  buffer_load_dwordx4 v12, s[28:31], s40 offen lds
  s_add_u32 s40, s40, s39
  s_mul_i32 s44, s19, 14336
  s_add_u32 s44, s44, s43
  s_add_u32 m0, s44, 86016
  s_nop 0
  buffer_load_dwordx4 v6, s[24:27], s41 offen lds
  s_add_u32 s41, s41, 2048
  s_add_u32 m0, s18, 100352
  s_nop 0
  buffer_load_dwordx4 v12, s[28:31], s40 offen lds
  s_add_u32 s40, s40, s39
  ds_read_b128 v[16:19], v10 offset:28672
  ds_read_b128 v[20:23], v10 offset:29696
  ds_read_b64_tr_b16 v[24:25], v11 offset:28672
  ds_read_b64_tr_b16 v[26:27], v11 offset:29696
  ds_read_b64_tr_b16 v[28:29], v11 offset:32768
  ds_read_b64_tr_b16 v[30:31], v11 offset:33792
  v_mfma_f32_32x32x16_bf16 v[64:79], v[32:35], v[40:43], v[64:79]
  v_mfma_f32_32x32x16_bf16 v[80:95], v[32:35], v[44:47], v[80:95]
  v_mfma_f32_32x32x16_bf16 v[96:111], v[36:39], v[40:43], v[96:111]
  v_mfma_f32_32x32x16_bf16 v[112:127], v[36:39], v[44:47], v[112:127]
  s_waitcnt lgkmcnt(0)
  ds_read_b128 v[32:35], v10 offset:43008
  ds_read_b128 v[36:39], v10 offset:44032
  ds_read_b64_tr_b16 v[40:41], v11 offset:43008
  ds_read_b64_tr_b16 v[42:43], v11 offset:44032
  ds_read_b64_tr_b16 v[44:45], v11 offset:47104
  ds_read_b64_tr_b16 v[46:47], v11 offset:48128
  v_mfma_f32_32x32x16_bf16 v[64:79], v[16:19], v[24:27], v[64:79]
  v_mfma_f32_32x32x16_bf16 v[80:95], v[16:19], v[28:31], v[80:95]
  v_mfma_f32_32x32x16_bf16 v[96:111], v[20:23], v[24:27], v[96:111]
  v_mfma_f32_32x32x16_bf16 v[112:127], v[20:23], v[28:31], v[112:127]
  s_waitcnt lgkmcnt(0)
  s_waitcnt vmcnt(3)
  s_barrier
  s_add_u32 m0, s18, 0
  s_nop 0
  buffer_load_dwordx4 v12, s[28:31], s40 offen lds
  s_add_u32 s40, s40, s39
  s_mul_i32 s44, s19, 14336
  s_add_u32 s44, s44, s43
  s_add_u32 m0, s44, 0
  s_nop 0
  buffer_load_dwordx4 v6, s[24:27], s41 offen lds
  s_add_u32 s41, s41, 2048
  s_add_u32 m0, s18, 14336
  s_nop 0
  buffer_load_dwordx4 v12, s[28:31], s40 offen lds
  s_add_u32 s40, s40, s39
  ds_read_b128 v[16:19], v13 offset:0
  ds_read_b128 v[20:23], v13 offset:1024
  ds_read_b64_tr_b16 v[24:25], v14 offset:0
  ds_read_b64_tr_b16 v[26:27], v14 offset:1024
  ds_read_b64_tr_b16 v[28:29], v14 offset:4096
  ds_read_b64_tr_b16 v[30:31], v14 offset:5120
  v_mfma_f32_32x32x16_bf16 v[64:79], v[32:35], v[40:43], v[64:79]
  v_mfma_f32_32x32x16_bf16 v[80:95], v[32:35], v[44:47], v[80:95]
  v_mfma_f32_32x32x16_bf16 v[96:111], v[36:39], v[40:43], v[96:111]
  v_mfma_f32_32x32x16_bf16 v[112:127], v[36:39], v[44:47], v[112:127]
  s_waitcnt lgkmcnt(0)
  ds_read_b128 v[32:35], v13 offset:14336
  ds_read_b128 v[36:39], v13 offset:15360
  ds_read_b64_tr_b16 v[40:41], v14 offset:14336
  ds_read_b64_tr_b16 v[42:43], v14 offset:15360
  ds_read_b64_tr_b16 v[44:45], v14 offset:18432
  ds_read_b64_tr_b16 v[46:47], v14 offset:19456
  v_mfma_f32_32x32x16_bf16 v[64:79], v[16:19], v[24:27], v[64:79]
  v_mfma_f32_32x32x16_bf16 v[80:95], v[16:19], v[28:31], v[80:95]
  v_mfma_f32_32x32x16_bf16 v[96:111], v[20:23], v[24:27], v[96:111]
  v_mfma_f32_32x32x16_bf16 v[112:127], v[20:23], v[28:31], v[112:127]
  s_waitcnt lgkmcnt(0)
  s_waitcnt vmcnt(3)
  s_barrier
  s_add_u32 m0, s18, 28672
  s_nop 0
  buffer_load_dwordx4 v12, s[28:31], s40 offen lds
  s_add_u32 s40, s40, s39
  s_mul_i32 s44, s19, 14336
  s_add_u32 s44, s44, s43
  s_add_u32 m0, s44, 28672
  s_nop 0
  buffer_load_dwordx4 v6, s[24:27], s41 offen lds
  s_add_u32 s41, s41, 2048
  s_add_u32 m0, s18, 43008
  s_nop 0
  buffer_load_dwordx4 v12, s[28:31], s40 offen lds
  s_add_u32 s40, s40, s39
  ds_read_b128 v[16:19], v13 offset:28672
  ds_read_b128 v[20:23], v13 offset:29696
  ds_read_b64_tr_b16 v[24:25], v14 offset:28672
  ds_read_b64_tr_b16 v[26:27], v14 offset:29696
  ds_read_b64_tr_b16 v[28:29], v14 offset:32768
  ds_read_b64_tr_b16 v[30:31], v14 offset:33792
  v_mfma_f32_32x32x16_bf16 v[64:79], v[32:35], v[40:43], v[64:79]
  v_mfma_f32_32x32x16_bf16 v[80:95], v[32:35], v[44:47], v[80:95]
  v_mfma_f32_32x32x16_bf16 v[96:111], v[36:39], v[40:43], v[96:111]
  v_mfma_f32_32x32x16_bf16 v[112:127], v[36:39], v[44:47], v[112:127]
  s_waitcnt lgkmcnt(0)
  ds_read_b128 v[32:35], v13 offset:43008
  ds_read_b128 v[36:39], v13 offset:44032
  ds_read_b64_tr_b16 v[40:41], v14 offset:43008
  ds_read_b64_tr_b16 v[42:43], v14 offset:44032
  ds_read_b64_tr_b16 v[44:45], v14 offset:47104
  ds_read_b64_tr_b16 v[46:47], v14 offset:48128
  v_mfma_f32_32x32x16_bf16 v[64:79], v[16:19], v[24:27], v[64:79]
  v_mfma_f32_32x32x16_bf16 v[80:95], v[16:19], v[28:31], v[80:95]
  v_mfma_f32_32x32x16_bf16 v[96:111], v[20:23], v[24:27], v[96:111]
  v_mfma_f32_32x32x16_bf16 v[112:127], v[20:23], v[28:31], v[112:127]
  s_waitcnt lgkmcnt(0)
  s_waitcnt vmcnt(3)
  s_barrier
  s_add_u32 m0, s18, 57344
  s_nop 0
  buffer_load_dwordx4 v12, s[28:31], s40 offen lds
  s_add_u32 s40, s40, s39
  s_mul_i32 s44, s19, 14336
  s_add_u32 s44, s44, s43
  s_add_u32 m0, s44, 57344
  s_nop 0
  buffer_load_dwordx4 v6, s[24:27], s41 offen lds
  s_add_u32 s41, s41, 2048
  s_add_u32 m0, s18, 71680
  s_nop 0
  buffer_load_dwordx4 v12, s[28:31], s40 offen lds
  s_add_u32 s40, s40, s39
  ds_read_b128 v[16:19], v10 offset:0
  ds_read_b128 v[20:23], v10 offset:1024
  ds_read_b64_tr_b16 v[24:25], v11 offset:0
  ds_read_b64_tr_b16 v[26:27], v11 offset:1024
  ds_read_b64_tr_b16 v[28:29], v11 offset:4096
  ds_read_b64_tr_b16 v[30:31], v11 offset:5120
  v_mfma_f32_32x32x16_bf16 v[64:79], v[32:35], v[40:43], v[64:79]
  v_mfma_f32_32x32x16_bf16 v[80:95], v[32:35], v[44:47], v[80:95]
  v_mfma_f32_32x32x16_bf16 v[96:111], v[36:39], v[40:43], v[96:111]
  v_mfma_f32_32x32x16_bf16 v[112:127], v[36:39], v[44:47], v[112:127]
  s_add_u32 s47, s47, 1
  s_cmp_lt_u32 s47, 4
  s_cbranch_scc1 K1_LV
  s_load_dwordx2 s[56:57], s[0:1], 48
  s_lshr_b32 s44, s2, 3
  s_lshl_b32 s44, s44, 3
  s_add_u32 s44, s44, s16
  s_mul_i32 s44, s44, 5504
  v_lshlrev_b32 v48, 7, v2
  v_cmp_gt_u32 vcc, 43, v2
  s_waitcnt lgkmcnt(0)
  s_mov_b32 s60, s56
  s_and_b32 s61, s57, 0xffff
  s_mov_b32 s62, 1409024
  s_mov_b32 s63, 0x20000
  s_and_saveexec_b64 s[56:57], vcc
  buffer_load_dword v49, v48, s[60:63], s44 offen
  s_mov_b64 exec, s[56:57]
  s_and_b32 s43, s15, 1
  s_lshl_b32 s43, s43, 20
  s_lshl_b32 s44, s21, 17
  s_add_u32 s43, s43, s44
  s_add_u32 s43, s43, 4194304
  s_lshl_b32 s44, s42, 10
  s_add_u32 s43, s43, s44
  v_lshrrev_b32 v9, 4, v3
  v_lshlrev_b32 v9, 16, v9
  v_lshl_add_u32 v9, v4, 8, v9
  v_lshl_add_u32 v9, v5, 4, v9
  v_add_u32 v9, s43, v9
  v_cvt_pk_bf16_f32 v16, v64, v65
  v_cvt_pk_bf16_f32 v17, v66, v67
  v_cvt_pk_bf16_f32 v18, v68, v69
  v_cvt_pk_bf16_f32 v19, v70, v71
  s_mov_b32 s45, 0
  buffer_store_dwordx4 v[16:19], v9, s[24:27], s45 offen sc0 sc1
  s_nop 1
  v_cvt_pk_bf16_f32 v16, v72, v73
  v_cvt_pk_bf16_f32 v17, v74, v75
  v_cvt_pk_bf16_f32 v18, v76, v77
  v_cvt_pk_bf16_f32 v19, v78, v79
  s_mov_b32 s45, 512
  buffer_store_dwordx4 v[16:19], v9, s[24:27], s45 offen sc0 sc1
  s_nop 1
  v_cvt_pk_bf16_f32 v16, v80, v81
  v_cvt_pk_bf16_f32 v17, v82, v83
  v_cvt_pk_bf16_f32 v18, v84, v85
  v_cvt_pk_bf16_f32 v19, v86, v87
  s_mov_b32 s45, 524288
  buffer_store_dwordx4 v[16:19], v9, s[24:27], s45 offen sc0 sc1
  s_nop 1
  v_cvt_pk_bf16_f32 v16, v88, v89
  v_cvt_pk_bf16_f32 v17, v90, v91
  v_cvt_pk_bf16_f32 v18, v92, v93
  v_cvt_pk_bf16_f32 v19, v94, v95
  s_mov_b32 s45, 524800
  buffer_store_dwordx4 v[16:19], v9, s[24:27], s45 offen sc0 sc1
  s_nop 1
  v_cvt_pk_bf16_f32 v16, v96, v97
  v_cvt_pk_bf16_f32 v17, v98, v99
  v_cvt_pk_bf16_f32 v18, v100, v101
  v_cvt_pk_bf16_f32 v19, v102, v103
  s_mov_b32 s45, 1024
  buffer_store_dwordx4 v[16:19], v9, s[24:27], s45 offen sc0 sc1
  s_nop 1
  v_cvt_pk_bf16_f32 v16, v104, v105
  v_cvt_pk_bf16_f32 v17, v106, v107
  v_cvt_pk_bf16_f32 v18, v108, v109
  v_cvt_pk_bf16_f32 v19, v110, v111
  s_mov_b32 s45, 1536
  buffer_store_dwordx4 v[16:19], v9, s[24:27], s45 offen sc0 sc1
  s_nop 1
  v_cvt_pk_bf16_f32 v16, v112, v113
  v_cvt_pk_bf16_f32 v17, v114, v115
  v_cvt_pk_bf16_f32 v18, v116, v117
  v_cvt_pk_bf16_f32 v19, v118, v119
  s_mov_b32 s45, 525312
  buffer_store_dwordx4 v[16:19], v9, s[24:27], s45 offen sc0 sc1
  s_nop 1
  v_cvt_pk_bf16_f32 v16, v120, v121
  v_cvt_pk_bf16_f32 v17, v122, v123
  v_cvt_pk_bf16_f32 v18, v124, v125
  v_cvt_pk_bf16_f32 v19, v126, v127
  s_mov_b32 s45, 525824
  buffer_store_dwordx4 v[16:19], v9, s[24:27], s45 offen sc0 sc1
  s_branch K1_FIN
K1_MINI:
  s_lshr_b32 s62, s15, 2
  s_add_u32 s62, s62, 40
  s_and_b32 s63, s15, 3
  s_cmp_ge_u32 s15, 12
  s_cselect_b32 s50, 0, s50
  s_cselect_b32 s54, 0, 1409024
  s_cselect_b32 s50, 0, s54
  v_lshrrev_b32 v7, 2, v2
  s_mov_b32 s56, 2752
  v_mul_lo_u32 v15, v7, s56
  v_and_b32 v8, 3, v2
  v_lshl_add_u32 v15, v8, 4, v15
  s_lshl_b32 s57, s62, 6
  v_add_u32 v15, s57, v15
  s_mov_b32 s40, 0
  s_mov_b32 m0, 12288
  s_nop 0
  buffer_load_dwordx4 v15, s[48:51], s40 offen lds
  s_mov_b32 m0, 13312
  s_nop 0
  buffer_load_dwordx4 v15, s[52:55], s40 offen lds
  s_add_u32 s40, s40, 44032
  s_mov_b32 m0, 26624
  s_nop 0
  buffer_load_dwordx4 v15, s[48:51], s40 offen lds
  s_mov_b32 m0, 27648
  s_nop 0
  buffer_load_dwordx4 v15, s[52:55], s40 offen lds
  s_add_u32 s40, s40, 44032
  s_mov_b32 m0, 40960
  s_nop 0
  buffer_load_dwordx4 v15, s[48:51], s40 offen lds
  s_mov_b32 m0, 41984
  s_nop 0
  buffer_load_dwordx4 v15, s[52:55], s40 offen lds
  s_add_u32 s40, s40, 44032
  s_mov_b32 m0, 55296
  s_nop 0
  buffer_load_dwordx4 v15, s[48:51], s40 offen lds
  s_mov_b32 m0, 56320
  s_nop 0
  buffer_load_dwordx4 v15, s[52:55], s40 offen lds
  s_add_u32 s40, s40, 44032
  s_mov_b32 m0, 69632
  s_nop 0
  buffer_load_dwordx4 v15, s[48:51], s40 offen lds
  s_mov_b32 m0, 70656
  s_nop 0
  buffer_load_dwordx4 v15, s[52:55], s40 offen lds
  s_add_u32 s40, s40, 44032
  s_mov_b32 m0, 83968
  s_nop 0
  buffer_load_dwordx4 v15, s[48:51], s40 offen lds
  s_mov_b32 m0, 84992
  s_nop 0
  buffer_load_dwordx4 v15, s[52:55], s40 offen lds
  s_add_u32 s40, s40, 44032
  v_and_b32 v7, 15, v2
  v_lshrrev_b32 v11, 2, v7
  v_lshrrev_b32 v8, 5, v2
  v_lshl_add_u32 v11, v8, 3, v11
  v_lshlrev_b32 v11, 6, v11
  v_and_b32 v7, 3, v7
  v_lshlrev_b32 v7, 3, v7
  v_bfe_u32 v8, v2, 4, 1
  v_lshl_add_u32 v7, v8, 5, v7
  v_add_u32 v11, v11, v7
  v_add_u32 v11, 12288, v11
  s_lshl_b32 s45, s63, 10
  s_add_u32 s45, s45, 8192
  v_add_u32 v10, s45, v6
  v_add_u32 v13, 57344, v10
  v_add_u32 v14, 57344, v11
  v_mov_b32 v64, 0
  v_mov_b32 v65, 0
  v_mov_b32 v66, 0
  v_mov_b32 v67, 0
  v_mov_b32 v68, 0
  v_mov_b32 v69, 0
  v_mov_b32 v70, 0
  v_mov_b32 v71, 0
  v_mov_b32 v72, 0
  v_mov_b32 v73, 0
  v_mov_b32 v74, 0
  v_mov_b32 v75, 0
  v_mov_b32 v76, 0
  v_mov_b32 v77, 0
  v_mov_b32 v78, 0
  v_mov_b32 v79, 0
  v_mov_b32 v80, 0
  v_mov_b32 v81, 0
  v_mov_b32 v82, 0
  v_mov_b32 v83, 0
  v_mov_b32 v84, 0
  v_mov_b32 v85, 0
  v_mov_b32 v86, 0
  v_mov_b32 v87, 0
  v_mov_b32 v88, 0
  v_mov_b32 v89, 0
  v_mov_b32 v90, 0
  v_mov_b32 v91, 0
  v_mov_b32 v92, 0
  v_mov_b32 v93, 0
  v_mov_b32 v94, 0
  v_mov_b32 v95, 0
  s_waitcnt vmcnt(8)
  s_barrier
  ds_read_b128 v[16:19], v10 offset:0
  ds_read_b64_tr_b16 v[24:25], v11 offset:0
  ds_read_b64_tr_b16 v[26:27], v11 offset:256
  ds_read_b64_tr_b16 v[28:29], v11 offset:1024
  ds_read_b64_tr_b16 v[30:31], v11 offset:1280
  s_mov_b32 s47, 0
K1_ML:
  s_waitcnt lgkmcnt(0)
  ds_read_b128 v[32:35], v10 offset:14336
  ds_read_b64_tr_b16 v[40:41], v11 offset:14336
  ds_read_b64_tr_b16 v[42:43], v11 offset:14592
  ds_read_b64_tr_b16 v[44:45], v11 offset:15360
  ds_read_b64_tr_b16 v[46:47], v11 offset:15616
  v_mfma_f32_32x32x16_bf16 v[64:79], v[24:27], v[16:19], v[64:79]
  v_mfma_f32_32x32x16_bf16 v[80:95], v[28:31], v[16:19], v[80:95]
  s_waitcnt lgkmcnt(0)
  s_waitcnt vmcnt(4)
  s_barrier
  s_mov_b32 m0, 98304
  s_nop 0
  buffer_load_dwordx4 v15, s[48:51], s40 offen lds
  s_mov_b32 m0, 99328
  s_nop 0
  buffer_load_dwordx4 v15, s[52:55], s40 offen lds
  s_add_u32 s40, s40, 44032
  s_mov_b32 m0, 112640
  s_nop 0
  buffer_load_dwordx4 v15, s[48:51], s40 offen lds
  s_mov_b32 m0, 113664
  s_nop 0
  buffer_load_dwordx4 v15, s[52:55], s40 offen lds
  s_add_u32 s40, s40, 44032
  ds_read_b128 v[16:19], v10 offset:28672
  ds_read_b64_tr_b16 v[24:25], v11 offset:28672
  ds_read_b64_tr_b16 v[26:27], v11 offset:28928
  ds_read_b64_tr_b16 v[28:29], v11 offset:29696
  ds_read_b64_tr_b16 v[30:31], v11 offset:29952
  v_mfma_f32_32x32x16_bf16 v[64:79], v[40:43], v[32:35], v[64:79]
  v_mfma_f32_32x32x16_bf16 v[80:95], v[44:47], v[32:35], v[80:95]
  s_waitcnt lgkmcnt(0)
  ds_read_b128 v[32:35], v10 offset:43008
  ds_read_b64_tr_b16 v[40:41], v11 offset:43008
  ds_read_b64_tr_b16 v[42:43], v11 offset:43264
  ds_read_b64_tr_b16 v[44:45], v11 offset:44032
  ds_read_b64_tr_b16 v[46:47], v11 offset:44288
  v_mfma_f32_32x32x16_bf16 v[64:79], v[24:27], v[16:19], v[64:79]
  v_mfma_f32_32x32x16_bf16 v[80:95], v[28:31], v[16:19], v[80:95]
  s_waitcnt lgkmcnt(0)
  s_waitcnt vmcnt(4)
  s_barrier
  s_mov_b32 m0, 12288
  s_nop 0
  buffer_load_dwordx4 v15, s[48:51], s40 offen lds
  s_mov_b32 m0, 13312
  s_nop 0
  buffer_load_dwordx4 v15, s[52:55], s40 offen lds
  s_add_u32 s40, s40, 44032
  s_mov_b32 m0, 26624
  s_nop 0
  buffer_load_dwordx4 v15, s[48:51], s40 offen lds
  s_mov_b32 m0, 27648
  s_nop 0
  buffer_load_dwordx4 v15, s[52:55], s40 offen lds
  s_add_u32 s40, s40, 44032
  ds_read_b128 v[16:19], v13 offset:0
  ds_read_b64_tr_b16 v[24:25], v14 offset:0
  ds_read_b64_tr_b16 v[26:27], v14 offset:256
  ds_read_b64_tr_b16 v[28:29], v14 offset:1024
  ds_read_b64_tr_b16 v[30:31], v14 offset:1280
  v_mfma_f32_32x32x16_bf16 v[64:79], v[40:43], v[32:35], v[64:79]
  v_mfma_f32_32x32x16_bf16 v[80:95], v[44:47], v[32:35], v[80:95]
  s_waitcnt lgkmcnt(0)
  ds_read_b128 v[32:35], v13 offset:14336
  ds_read_b64_tr_b16 v[40:41], v14 offset:14336
  ds_read_b64_tr_b16 v[42:43], v14 offset:14592
  ds_read_b64_tr_b16 v[44:45], v14 offset:15360
  ds_read_b64_tr_b16 v[46:47], v14 offset:15616
  v_mfma_f32_32x32x16_bf16 v[64:79], v[24:27], v[16:19], v[64:79]
  v_mfma_f32_32x32x16_bf16 v[80:95], v[28:31], v[16:19], v[80:95]
  s_waitcnt lgkmcnt(0)
  s_waitcnt vmcnt(4)
  s_barrier
  s_mov_b32 m0, 40960
  s_nop 0
  buffer_load_dwordx4 v15, s[48:51], s40 offen lds
  s_mov_b32 m0, 41984
  s_nop 0
  buffer_load_dwordx4 v15, s[52:55], s40 offen lds
  s_add_u32 s40, s40, 44032
  s_mov_b32 m0, 55296
  s_nop 0
  buffer_load_dwordx4 v15, s[48:51], s40 offen lds
  s_mov_b32 m0, 56320
  s_nop 0
  buffer_load_dwordx4 v15, s[52:55], s40 offen lds
  s_add_u32 s40, s40, 44032
  ds_read_b128 v[16:19], v13 offset:28672
  ds_read_b64_tr_b16 v[24:25], v14 offset:28672
  ds_read_b64_tr_b16 v[26:27], v14 offset:28928
  ds_read_b64_tr_b16 v[28:29], v14 offset:29696
  ds_read_b64_tr_b16 v[30:31], v14 offset:29952
  v_mfma_f32_32x32x16_bf16 v[64:79], v[40:43], v[32:35], v[64:79]
  v_mfma_f32_32x32x16_bf16 v[80:95], v[44:47], v[32:35], v[80:95]
  s_waitcnt lgkmcnt(0)
  ds_read_b128 v[32:35], v13 offset:43008
  ds_read_b64_tr_b16 v[40:41], v14 offset:43008
  ds_read_b64_tr_b16 v[42:43], v14 offset:43264
  ds_read_b64_tr_b16 v[44:45], v14 offset:44032
  ds_read_b64_tr_b16 v[46:47], v14 offset:44288
  v_mfma_f32_32x32x16_bf16 v[64:79], v[24:27], v[16:19], v[64:79]
  v_mfma_f32_32x32x16_bf16 v[80:95], v[28:31], v[16:19], v[80:95]
  s_waitcnt lgkmcnt(0)
  s_waitcnt vmcnt(4)
  s_barrier
  s_mov_b32 m0, 69632
  s_nop 0
  buffer_load_dwordx4 v15, s[48:51], s40 offen lds
  s_mov_b32 m0, 70656
  s_nop 0
  buffer_load_dwordx4 v15, s[52:55], s40 offen lds
  s_add_u32 s40, s40, 44032
  s_mov_b32 m0, 83968
  s_nop 0
  buffer_load_dwordx4 v15, s[48:51], s40 offen lds
  s_mov_b32 m0, 84992
  s_nop 0
  buffer_load_dwordx4 v15, s[52:55], s40 offen lds
  s_add_u32 s40, s40, 44032
  ds_read_b128 v[16:19], v10 offset:0
  ds_read_b64_tr_b16 v[24:25], v11 offset:0
  ds_read_b64_tr_b16 v[26:27], v11 offset:256
  ds_read_b64_tr_b16 v[28:29], v11 offset:1024
  ds_read_b64_tr_b16 v[30:31], v11 offset:1280
  v_mfma_f32_32x32x16_bf16 v[64:79], v[40:43], v[32:35], v[64:79]
  v_mfma_f32_32x32x16_bf16 v[80:95], v[44:47], v[32:35], v[80:95]
  s_add_u32 s47, s47, 1
  s_cmp_lt_u32 s47, 4
  s_cbranch_scc1 K1_ML
  s_cmp_ge_u32 s15, 12
  s_cbranch_scc1 K1_FIN
  s_mov_b32 s43, s62
  s_lshl_b32 s45, s14, 2
  s_add_u32 s45, s45, s63
  s_mul_i32 s45, s45, 88064
  s_lshl_b32 s43, s43, 11
  s_add_u32 s43, s43, s45
  s_add_u32 s43, s43, 6291456
  v_add_u32 v9, s43, v6
  v_cvt_pk_bf16_f32 v20, v64, v65
  v_cvt_pk_bf16_f32 v21, v80, v81
  v_lshlrev_b32 v22, 16, v20
  v_and_b32 v23, 0xffff0000, v20
  v_lshlrev_b32 v24, 16, v21
  v_and_b32 v25, 0xffff0000, v21
  v_mul_f32 v26, s46, v22
  v_exp_f32 v26, v26
  s_nop 0
  v_add_f32 v26, 1.0, v26
  v_rcp_f32 v26, v26
  s_nop 0
  v_mul_f32 v22, v22, v26
  v_mul_f32 v26, s46, v23
  v_exp_f32 v26, v26
  s_nop 0
  v_add_f32 v26, 1.0, v26
  v_rcp_f32 v26, v26
  s_nop 0
  v_mul_f32 v23, v23, v26
  v_cvt_pk_bf16_f32 v20, v22, v23
  v_lshlrev_b32 v22, 16, v20
  v_and_b32 v23, 0xffff0000, v20
  v_mul_f32 v22, v22, v24
  v_mul_f32 v23, v23, v25
  v_cvt_pk_bf16_f32 v16, v22, v23
  v_cvt_pk_bf16_f32 v20, v66, v67
  v_cvt_pk_bf16_f32 v21, v82, v83
  v_lshlrev_b32 v22, 16, v20
  v_and_b32 v23, 0xffff0000, v20
  v_lshlrev_b32 v24, 16, v21
  v_and_b32 v25, 0xffff0000, v21
  v_mul_f32 v26, s46, v22
  v_exp_f32 v26, v26
  s_nop 0
  v_add_f32 v26, 1.0, v26
  v_rcp_f32 v26, v26
  s_nop 0
  v_mul_f32 v22, v22, v26
  v_mul_f32 v26, s46, v23
  v_exp_f32 v26, v26
  s_nop 0
  v_add_f32 v26, 1.0, v26
  v_rcp_f32 v26, v26
  s_nop 0
  v_mul_f32 v23, v23, v26
  v_cvt_pk_bf16_f32 v20, v22, v23
  v_lshlrev_b32 v22, 16, v20
  v_and_b32 v23, 0xffff0000, v20
  v_mul_f32 v22, v22, v24
  v_mul_f32 v23, v23, v25
  v_cvt_pk_bf16_f32 v17, v22, v23
  v_cvt_pk_bf16_f32 v20, v68, v69
  v_cvt_pk_bf16_f32 v21, v84, v85
  v_lshlrev_b32 v22, 16, v20
  v_and_b32 v23, 0xffff0000, v20
  v_lshlrev_b32 v24, 16, v21
  v_and_b32 v25, 0xffff0000, v21
  v_mul_f32 v26, s46, v22
  v_exp_f32 v26, v26
  s_nop 0
  v_add_f32 v26, 1.0, v26
  v_rcp_f32 v26, v26
  s_nop 0
  v_mul_f32 v22, v22, v26
  v_mul_f32 v26, s46, v23
  v_exp_f32 v26, v26
  s_nop 0
  v_add_f32 v26, 1.0, v26
  v_rcp_f32 v26, v26
  s_nop 0
  v_mul_f32 v23, v23, v26
  v_cvt_pk_bf16_f32 v20, v22, v23
  v_lshlrev_b32 v22, 16, v20
  v_and_b32 v23, 0xffff0000, v20
  v_mul_f32 v22, v22, v24
  v_mul_f32 v23, v23, v25
  v_cvt_pk_bf16_f32 v18, v22, v23
  v_cvt_pk_bf16_f32 v20, v70, v71
  v_cvt_pk_bf16_f32 v21, v86, v87
  v_lshlrev_b32 v22, 16, v20
  v_and_b32 v23, 0xffff0000, v20
  v_lshlrev_b32 v24, 16, v21
  v_and_b32 v25, 0xffff0000, v21
  v_mul_f32 v26, s46, v22
  v_exp_f32 v26, v26
  s_nop 0
  v_add_f32 v26, 1.0, v26
  v_rcp_f32 v26, v26
  s_nop 0
  v_mul_f32 v22, v22, v26
  v_mul_f32 v26, s46, v23
  v_exp_f32 v26, v26
  s_nop 0
  v_add_f32 v26, 1.0, v26
  v_rcp_f32 v26, v26
  s_nop 0
  v_mul_f32 v23, v23, v26
  v_cvt_pk_bf16_f32 v20, v22, v23
  v_lshlrev_b32 v22, 16, v20
  v_and_b32 v23, 0xffff0000, v20
  v_mul_f32 v22, v22, v24
  v_mul_f32 v23, v23, v25
  v_cvt_pk_bf16_f32 v19, v22, v23
  s_mov_b32 s47, 0
  buffer_store_dwordx4 v[16:19], v9, s[24:27], s47 offen sc0 sc1
  v_cvt_pk_bf16_f32 v20, v72, v73
  v_cvt_pk_bf16_f32 v21, v88, v89
  v_lshlrev_b32 v22, 16, v20
  v_and_b32 v23, 0xffff0000, v20
  v_lshlrev_b32 v24, 16, v21
  v_and_b32 v25, 0xffff0000, v21
  v_mul_f32 v26, s46, v22
  v_exp_f32 v26, v26
  s_nop 0
  v_add_f32 v26, 1.0, v26
  v_rcp_f32 v26, v26
  s_nop 0
  v_mul_f32 v22, v22, v26
  v_mul_f32 v26, s46, v23
  v_exp_f32 v26, v26
  s_nop 0
  v_add_f32 v26, 1.0, v26
  v_rcp_f32 v26, v26
  s_nop 0
  v_mul_f32 v23, v23, v26
  v_cvt_pk_bf16_f32 v20, v22, v23
  v_lshlrev_b32 v22, 16, v20
  v_and_b32 v23, 0xffff0000, v20
  v_mul_f32 v22, v22, v24
  v_mul_f32 v23, v23, v25
  v_cvt_pk_bf16_f32 v16, v22, v23
  v_cvt_pk_bf16_f32 v20, v74, v75
  v_cvt_pk_bf16_f32 v21, v90, v91
  v_lshlrev_b32 v22, 16, v20
  v_and_b32 v23, 0xffff0000, v20
  v_lshlrev_b32 v24, 16, v21
  v_and_b32 v25, 0xffff0000, v21
  v_mul_f32 v26, s46, v22
  v_exp_f32 v26, v26
  s_nop 0
  v_add_f32 v26, 1.0, v26
  v_rcp_f32 v26, v26
  s_nop 0
  v_mul_f32 v22, v22, v26
  v_mul_f32 v26, s46, v23
  v_exp_f32 v26, v26
  s_nop 0
  v_add_f32 v26, 1.0, v26
  v_rcp_f32 v26, v26
  s_nop 0
  v_mul_f32 v23, v23, v26
  v_cvt_pk_bf16_f32 v20, v22, v23
  v_lshlrev_b32 v22, 16, v20
  v_and_b32 v23, 0xffff0000, v20
  v_mul_f32 v22, v22, v24
  v_mul_f32 v23, v23, v25
  v_cvt_pk_bf16_f32 v17, v22, v23
  v_cvt_pk_bf16_f32 v20, v76, v77
  v_cvt_pk_bf16_f32 v21, v92, v93
  v_lshlrev_b32 v22, 16, v20
  v_and_b32 v23, 0xffff0000, v20
  v_lshlrev_b32 v24, 16, v21
  v_and_b32 v25, 0xffff0000, v21
  v_mul_f32 v26, s46, v22
  v_exp_f32 v26, v26
  s_nop 0
  v_add_f32 v26, 1.0, v26
  v_rcp_f32 v26, v26
  s_nop 0
  v_mul_f32 v22, v22, v26
  v_mul_f32 v26, s46, v23
  v_exp_f32 v26, v26
  s_nop 0
  v_add_f32 v26, 1.0, v26
  v_rcp_f32 v26, v26
  s_nop 0
  v_mul_f32 v23, v23, v26
  v_cvt_pk_bf16_f32 v20, v22, v23
  v_lshlrev_b32 v22, 16, v20
  v_and_b32 v23, 0xffff0000, v20
  v_mul_f32 v22, v22, v24
  v_mul_f32 v23, v23, v25
  v_cvt_pk_bf16_f32 v18, v22, v23
  v_cvt_pk_bf16_f32 v20, v78, v79
  v_cvt_pk_bf16_f32 v21, v94, v95
  v_lshlrev_b32 v22, 16, v20
  v_and_b32 v23, 0xffff0000, v20
  v_lshlrev_b32 v24, 16, v21
  v_and_b32 v25, 0xffff0000, v21
  v_mul_f32 v26, s46, v22
  v_exp_f32 v26, v26
  s_nop 0
  v_add_f32 v26, 1.0, v26
  v_rcp_f32 v26, v26
  s_nop 0
  v_mul_f32 v22, v22, v26
  v_mul_f32 v26, s46, v23
  v_exp_f32 v26, v26
  s_nop 0
  v_add_f32 v26, 1.0, v26
  v_rcp_f32 v26, v26
  s_nop 0
  v_mul_f32 v23, v23, v26
  v_cvt_pk_bf16_f32 v20, v22, v23
  v_lshlrev_b32 v22, 16, v20
  v_and_b32 v23, 0xffff0000, v20
  v_mul_f32 v22, v22, v24
  v_mul_f32 v23, v23, v25
  v_cvt_pk_bf16_f32 v19, v22, v23
  s_mov_b32 s47, 1024
  buffer_store_dwordx4 v[16:19], v9, s[24:27], s47 offen sc0 sc1
K1_FIN:
K1_END:
  s_endpgm
.globl k2_kernel
.p2align 8
.type k2_kernel,@function
k2_kernel:
  s_cmp_ge_u32 s2, 256
  s_cbranch_scc1 K2_END
  s_load_dwordx2 s[12:13], s[0:1], 72
  s_load_dwordx2 s[4:5], s[0:1], 0
  s_load_dwordx2 s[6:7], s[0:1], 48
  s_and_b32 s14, s2, 31
  s_lshr_b32 s15, s2, 5
  s_and_b32 s50, s2, 7
  s_lshl_b32 s50, s50, 3
  s_bfe_u32 s51, s2, 0x30003
  s_add_u32 s50, s50, s51
  s_lshr_b32 s51, s2, 6
  v_lshrrev_b32 v1, 6, v0
  s_nop 0
  v_readfirstlane_b32 s16, v1
  v_and_b32 v2, 63, v0
  s_waitcnt lgkmcnt(0)
  s_mov_b32 s24, s12
  s_and_b32 s25, s13, 0xffff
  s_mov_b32 s26, 268435456
  s_mov_b32 s27, 0x20000
  v_lshlrev_b32 v3, 4, v2
  s_cmp_ge_u32 s16, 8
  s_cbranch_scc1 K2_DOWN
  s_lshl_b32 s17, s14, 16
  s_lshl_b32 s22, s15, 3
  s_add_u32 s22, s22, s16
  s_lshl_b32 s23, s22, 10
  s_add_u32 s23, s23, s17
  s_add_u32 s23, s23, 0
  buffer_load_dwordx4 v[8:11], v3, s[24:27], s23 offen
  s_lshl_b32 s18, s16, 13
  s_add_u32 s19, s17, s18
  s_add_u32 s20, s19, 2097152
  s_add_u32 s21, s19, 4194304
  s_mov_b32 s28, 0
K2_DMA:
  s_add_u32 m0, s18, s28
  s_nop 0
  buffer_load_dwordx4 v3, s[24:27], s20 offen lds
  s_add_u32 s20, s20, 1024
  s_add_u32 s28, s28, 1024
  s_cmp_lt_u32 s28, 8192
  s_cbranch_scc1 K2_DMA
  s_add_u32 s29, s18, 57344
K2_DMAV:
  s_add_u32 m0, s29, s28
  s_nop 0
  buffer_load_dwordx4 v3, s[24:27], s21 offen lds
  s_add_u32 s21, s21, 1024
  s_add_u32 s28, s28, 1024
  s_cmp_lt_u32 s28, 16384
  s_cbranch_scc1 K2_DMAV
  v_and_b32 v4, 31, v2
  v_lshrrev_b32 v5, 5, v2
  v_and_b32 v6, 15, v2
  v_lshlrev_b32 v6, 4, v6
  v_lshl_add_u32 v6, v5, 8, v6
  v_add_u32 v6, 0x10000, v6
  v_cmp_gt_u32 s[30:31], 16, v4
  v_cmp_eq_u32 vcc, 16, v4
  v_mov_b32 v7, 0x3f803f80
  s_nop 0
  v_cndmask_b32 v7, 0, v7, vcc
  v_mov_b32 v40, v7
  v_mov_b32 v41, v7
  v_mov_b32 v42, v7
  v_mov_b32 v43, v7
  v_mov_b32 v44, v7
  v_mov_b32 v45, v7
  v_mov_b32 v46, v7
  v_mov_b32 v47, v7
  v_mov_b32 v48, v7
  v_mov_b32 v49, v7
  v_mov_b32 v50, v7
  v_mov_b32 v51, v7
  v_mov_b32 v52, v7
  v_mov_b32 v53, v7
  v_mov_b32 v54, v7
  v_mov_b32 v55, v7
  v_mov_b32 v20, 0xff800000
  v_mov_b32 v21, 0xff800000
  v_mov_b32 v22, v3
  s_waitcnt vmcnt(8)
  s_barrier
  s_and_b32 s40, s2, 7
  s_lshl_b32 s40, s40, 2
  s_bfe_u32 s41, s2, 0x20003
  s_add_u32 s40, s40, s41
  s_mul_i32 s40, s40, 176128
  s_add_u32 s32, s12, 6291456
  s_addc_u32 s33, s13, 0
  s_add_u32 s32, s32, s40
  s_addc_u32 s33, s33, 0
  s_and_b32 s33, s33, 0xffff
  s_mov_b32 s34, 176128
  s_mov_b32 s35, 0x20000
  s_mov_b32 s36, s6
  s_and_b32 s37, s7, 0xffff
  s_mov_b32 s38, 1409024
  s_mov_b32 s39, 0x20000
  v_lshlrev_b32 v34, 7, v2
  s_lshl_b32 s40, s16, 13
  buffer_load_dword v36, v34, s[32:35], s40 offen
  s_add_u32 s40, s40, 65536
  buffer_load_dword v36, v34, s[32:35], s40 offen
  s_add_u32 s40, s40, 65536
  buffer_load_dword v36, v34, s[32:35], s40 offen
  s_add_u32 s40, s40, 65536
  v_lshlrev_b32 v34, 10, v2
  s_lshr_b32 s41, s2, 5
  s_lshl_b32 s41, s41, 7
  v_add_u32 v34, s41, v34
  s_lshl_b32 s40, s16, 16
  buffer_load_dword v36, v34, s[36:39], s40 offen
  s_add_u32 s40, s40, 524288
  buffer_load_dword v36, v34, s[36:39], s40 offen
  s_add_u32 s40, s40, 524288
  buffer_load_dword v36, v34, s[36:39], s40 offen
  s_add_u32 s40, s40, 524288
  s_load_dwordx2 s[56:57], s[0:1], 16
  s_lshr_b32 s40, s2, 3
  s_lshl_b32 s40, s40, 3
  s_add_u32 s40, s40, s16
  s_lshl_b32 s40, s40, 11
  v_and_b32 v34, 15, v2
  v_lshlrev_b32 v34, 7, v34
  s_waitcnt lgkmcnt(0)
  s_mov_b32 s60, s56
  s_and_b32 s61, s57, 0xffff
  s_mov_b32 s62, 524288
  s_mov_b32 s63, 0x20000
  buffer_load_dword v36, v34, s[60:63], s40 offen
  s_mov_b32 s52, 4
K2_P1E:
  v_mov_b32 v20, 0xff800000
  v_mov_b32 v21, 0xff800000
  v_mov_b32 v22, v3
  ds_read_b128 v[12:15], v22 offset:0
  s_waitcnt lgkmcnt(0)
  v_mfma_f32_32x32x16_bf16 v[64:79], v[12:15], v[8:11], 0
  ds_read_b128 v[16:19], v22 offset:1024
  s_mov_b32 s28, 0
K2_P1:
  s_waitcnt lgkmcnt(0)
  v_mfma_f32_32x32x16_bf16 v[80:95], v[16:19], v[8:11], 0
  ds_read_b128 v[12:15], v22 offset:2048
  s_nop 6
  v_max3_f32 v20, v20, v64, v65
  v_max3_f32 v20, v20, v66, v67
  v_max3_f32 v20, v20, v68, v69
  v_max3_f32 v20, v20, v70, v71
  v_max3_f32 v20, v20, v72, v73
  v_max3_f32 v20, v20, v74, v75
  v_max3_f32 v20, v20, v76, v77
  v_max3_f32 v20, v20, v78, v79
  s_waitcnt lgkmcnt(0)
  v_mfma_f32_32x32x16_bf16 v[64:79], v[12:15], v[8:11], 0
  ds_read_b128 v[16:19], v22 offset:3072
  v_max3_f32 v21, v21, v80, v81
  v_max3_f32 v21, v21, v82, v83
  v_max3_f32 v21, v21, v84, v85
  v_max3_f32 v21, v21, v86, v87
  v_max3_f32 v21, v21, v88, v89
  v_max3_f32 v21, v21, v90, v91
  v_max3_f32 v21, v21, v92, v93
  v_max3_f32 v21, v21, v94, v95
  s_waitcnt lgkmcnt(0)
  v_mfma_f32_32x32x16_bf16 v[80:95], v[16:19], v[8:11], 0
  ds_read_b128 v[12:15], v22 offset:4096
  v_max3_f32 v20, v20, v64, v65
  v_max3_f32 v20, v20, v66, v67
  v_max3_f32 v20, v20, v68, v69
  v_max3_f32 v20, v20, v70, v71
  v_max3_f32 v20, v20, v72, v73
  v_max3_f32 v20, v20, v74, v75
  v_max3_f32 v20, v20, v76, v77
  v_max3_f32 v20, v20, v78, v79
  s_waitcnt lgkmcnt(0)
  v_mfma_f32_32x32x16_bf16 v[64:79], v[12:15], v[8:11], 0
  ds_read_b128 v[16:19], v22 offset:5120
  v_max3_f32 v21, v21, v80, v81
  v_max3_f32 v21, v21, v82, v83
  v_max3_f32 v21, v21, v84, v85
  v_max3_f32 v21, v21, v86, v87
  v_max3_f32 v21, v21, v88, v89
  v_max3_f32 v21, v21, v90, v91
  v_max3_f32 v21, v21, v92, v93
  v_max3_f32 v21, v21, v94, v95
  v_add_u32 v22, 4096, v22
  s_add_u32 s28, s28, 4
  s_cmp_lt_u32 s28, s52
  s_cbranch_scc1 K2_P1
  v_max_f32 v20, v20, v21
  v_mov_b32 v21, v20
  s_nop 1
  v_permlane32_swap_b32 v20, v21
  v_max_f32 v20, v20, v21
  s_cmp_eq_u32 s52, 4
  s_cselect_b32 s53, 0xc2800000, 0
  v_sub_f32 v20, s53, v20
  v_mov_b32 v112, v20
  v_mov_b32 v113, v20
  v_mov_b32 v114, v20
  v_mov_b32 v115, v20
  v_mov_b32 v116, v20
  v_mov_b32 v117, v20
  v_mov_b32 v118, v20
  v_mov_b32 v119, v20
  v_mov_b32 v120, v20
  v_mov_b32 v121, v20
  v_mov_b32 v122, v20
  v_mov_b32 v123, v20
  v_mov_b32 v124, v20
  v_mov_b32 v125, v20
  v_mov_b32 v126, v20
  v_mov_b32 v127, v20
  v_mov_b32 v96, 0
  v_mov_b32 v97, 0
  v_mov_b32 v98, 0
  v_mov_b32 v99, 0
  v_mov_b32 v100, 0
  v_mov_b32 v101, 0
  v_mov_b32 v102, 0
  v_mov_b32 v103, 0
  v_mov_b32 v104, 0
  v_mov_b32 v105, 0
  v_mov_b32 v106, 0
  v_mov_b32 v107, 0
  v_mov_b32 v108, 0
  v_mov_b32 v109, 0
  v_mov_b32 v110, 0
  v_mov_b32 v111, 0
  s_cmp_lg_u32 s52, 4
  s_cbranch_scc1 K2_NOBAR
  s_waitcnt vmcnt(7)
  s_barrier
K2_NOBAR:
  v_mov_b32 v22, v3
  v_mov_b32 v23, v6
  s_waitcnt lgkmcnt(0)
  ds_read_b128 v[12:15], v22 offset:0
  s_waitcnt lgkmcnt(0)
  v_mfma_f32_32x32x16_bf16 v[64:79], v[12:15], v[8:11], v[112:127]
  ds_read_b128 v[16:19], v22 offset:1024
  s_mov_b64 exec, s[30:31]
  ds_read_b128 v[40:43], v23 offset:0
  ds_read_b128 v[44:47], v23 offset:512
  s_mov_b64 exec, -1
  s_mov_b32 s28, 0
K2_P2:
  s_waitcnt lgkmcnt(0)
  v_mfma_f32_32x32x16_bf16 v[80:95], v[16:19], v[8:11], v[112:127]
  ds_read_b128 v[12:15], v22 offset:2048
  s_mov_b64 exec, s[30:31]
  ds_read_b128 v[48:51], v23 offset:1024
  ds_read_b128 v[52:55], v23 offset:1536
  s_mov_b64 exec, -1
  v_exp_f32 v64, v64
  v_exp_f32 v65, v65
  v_exp_f32 v66, v66
  v_exp_f32 v67, v67
  v_cvt_pk_bf16_f32 v24, v64, v65
  v_exp_f32 v68, v68
  v_exp_f32 v69, v69
  v_cvt_pk_bf16_f32 v25, v66, v67
  v_exp_f32 v70, v70
  v_exp_f32 v71, v71
  v_cvt_pk_bf16_f32 v26, v68, v69
  v_exp_f32 v72, v72
  v_exp_f32 v73, v73
  v_cvt_pk_bf16_f32 v27, v70, v71
  v_exp_f32 v74, v74
  v_exp_f32 v75, v75
  v_cvt_pk_bf16_f32 v28, v72, v73
  v_mfma_f32_32x32x16_bf16 v[96:111], v[40:43], v[24:27], v[96:111]
  v_exp_f32 v76, v76
  v_exp_f32 v77, v77
  v_cvt_pk_bf16_f32 v29, v74, v75
  v_exp_f32 v78, v78
  v_exp_f32 v79, v79
  v_cvt_pk_bf16_f32 v30, v76, v77
  v_cvt_pk_bf16_f32 v31, v78, v79
  s_nop 1
  v_mfma_f32_32x32x16_bf16 v[96:111], v[44:47], v[28:31], v[96:111]
  s_waitcnt lgkmcnt(0)
  v_mfma_f32_32x32x16_bf16 v[64:79], v[12:15], v[8:11], v[112:127]
  ds_read_b128 v[16:19], v22 offset:3072
  s_mov_b64 exec, s[30:31]
  ds_read_b128 v[40:43], v23 offset:2048
  ds_read_b128 v[44:47], v23 offset:2560
  s_mov_b64 exec, -1
  v_exp_f32 v80, v80
  v_exp_f32 v81, v81
  v_exp_f32 v82, v82
  v_exp_f32 v83, v83
  v_cvt_pk_bf16_f32 v24, v80, v81
  v_exp_f32 v84, v84
  v_exp_f32 v85, v85
  v_cvt_pk_bf16_f32 v25, v82, v83
  v_exp_f32 v86, v86
  v_exp_f32 v87, v87
  v_cvt_pk_bf16_f32 v26, v84, v85
  v_exp_f32 v88, v88
  v_exp_f32 v89, v89
  v_cvt_pk_bf16_f32 v27, v86, v87
  v_exp_f32 v90, v90
  v_exp_f32 v91, v91
  v_cvt_pk_bf16_f32 v28, v88, v89
  v_mfma_f32_32x32x16_bf16 v[96:111], v[48:51], v[24:27], v[96:111]
  v_exp_f32 v92, v92
  v_exp_f32 v93, v93
  v_cvt_pk_bf16_f32 v29, v90, v91
  v_exp_f32 v94, v94
  v_exp_f32 v95, v95
  v_cvt_pk_bf16_f32 v30, v92, v93
  v_cvt_pk_bf16_f32 v31, v94, v95
  s_nop 1
  v_mfma_f32_32x32x16_bf16 v[96:111], v[52:55], v[28:31], v[96:111]
  v_add_u32 v22, 2048, v22
  v_add_u32 v23, 2048, v23
  s_add_u32 s28, s28, 2
  s_cmp_lt_u32 s28, 64
  s_cbranch_scc1 K2_P2
  s_cmp_lg_u32 s52, 4
  s_nop 4
  s_cbranch_scc1 K2_OK
  s_mov_b64 s[54:55], 0
  v_mov_b32 v26, 0x207
  v_cmp_class_f32 vcc, v96, v26
  s_nop 3
  s_or_b64 s[54:55], s[54:55], vcc
  v_cmp_class_f32 vcc, v97, v26
  s_nop 3
  s_or_b64 s[54:55], s[54:55], vcc
  v_cmp_class_f32 vcc, v98, v26
  s_nop 3
  s_or_b64 s[54:55], s[54:55], vcc
  v_cmp_class_f32 vcc, v99, v26
  s_nop 3
  s_or_b64 s[54:55], s[54:55], vcc
  v_cmp_class_f32 vcc, v100, v26
  s_nop 3
  s_or_b64 s[54:55], s[54:55], vcc
  v_cmp_class_f32 vcc, v101, v26
  s_nop 3
  s_or_b64 s[54:55], s[54:55], vcc
  v_cmp_class_f32 vcc, v102, v26
  s_nop 3
  s_or_b64 s[54:55], s[54:55], vcc
  v_cmp_class_f32 vcc, v103, v26
  s_nop 3
  s_or_b64 s[54:55], s[54:55], vcc
  v_cmp_class_f32 vcc, v104, v26
  s_nop 3
  s_or_b64 s[54:55], s[54:55], vcc
  s_cmp_eq_u64 s[54:55], 0
  s_cbranch_scc1 K2_OK
  s_mov_b32 s52, 64
  s_branch K2_P1E
K2_OK:
  v_mov_b32 v20, v104
  v_mov_b32 v21, v104
  s_nop 1
  v_permlane32_swap_b32 v20, v21
  v_rcp_f32 v21, v20
  s_nop 0
  v_mul_f32 v26, v96, v21
  v_fma_f32 v27, -v26, v20, v96
  v_fma_f32 v96, v27, v21, v26
  v_mul_f32 v26, v97, v21
  v_fma_f32 v27, -v26, v20, v97
  v_fma_f32 v97, v27, v21, v26
  v_mul_f32 v26, v98, v21
  v_fma_f32 v27, -v26, v20, v98
  v_fma_f32 v98, v27, v21, v26
  v_mul_f32 v26, v99, v21
  v_fma_f32 v27, -v26, v20, v99
  v_fma_f32 v99, v27, v21, v26
  v_mul_f32 v26, v100, v21
  v_fma_f32 v27, -v26, v20, v100
  v_fma_f32 v100, v27, v21, v26
  v_mul_f32 v26, v101, v21
  v_fma_f32 v27, -v26, v20, v101
  v_fma_f32 v101, v27, v21, v26
  v_mul_f32 v26, v102, v21
  v_fma_f32 v27, -v26, v20, v102
  v_fma_f32 v102, v27, v21, v26
  v_mul_f32 v26, v103, v21
  v_fma_f32 v27, -v26, v20, v103
  v_fma_f32 v103, v27, v21, v26
  v_cvt_pk_bf16_f32 v28, v96, v97
  v_cvt_pk_bf16_f32 v29, v98, v99
  v_cvt_pk_bf16_f32 v30, v100, v101
  v_cvt_pk_bf16_f32 v31, v102, v103
  s_lshl_b32 s23, s22, 15
  s_lshl_b32 s29, s14, 10
  s_add_u32 s23, s23, s29
  s_add_u32 s23, s23, 12582912
  buffer_store_dwordx4 v[28:31], v3, s[24:27], s23 offen sc0 sc1
  s_branch K2_END
K2_DOWN:
  s_sub_u32 s17, s16, 8
  s_and_b32 s19, s2, 7
  s_lshl_b32 s19, s19, 2
  s_bfe_u32 s20, s2, 0x20003
  s_add_u32 s19, s19, s20
  s_lshr_b32 s20, s2, 5
  s_mov_b32 s28, s6
  s_and_b32 s29, s7, 0xffff
  s_mov_b32 s30, 1409024
  s_mov_b32 s31, 0x20000
  s_add_u32 s32, s12, 6291456
  s_addc_u32 s33, s13, 0
  s_and_b32 s33, s33, 0xffff
  s_mov_b32 s34, 5636096
  s_mov_b32 s35, 0x20000
  s_mov_b32 s36, s4
  s_and_b32 s37, s5, 0xffff
  s_mov_b32 s38, 2097152
  s_mov_b32 s39, 0x20000
  v_bfe_u32 v7, v2, 3, 2
  v_bfe_u32 v8, v2, 5, 1
  v_lshl_add_u32 v7, v8, 3, v7
  v_lshlrev_b32 v12, 10, v7
  v_bfe_u32 v7, v2, 2, 1
  v_bfe_u32 v8, v2, 4, 1
  v_xor_b32 v7, v7, v8
  v_lshl_add_u32 v12, v7, 6, v12
  v_and_b32 v8, 3, v2
  v_lshl_add_u32 v12, v8, 4, v12
  s_lshl_b32 s21, s20, 7
  v_add_u32 v12, s21, v12
  v_add_u32 v13, 4096, v12
  v_and_b32 v5, 15, v2
  v_lshrrev_b32 v4, 5, v2
  v_lshrrev_b32 v7, 2, v5
  v_lshl_add_u32 v11, v4, 3, v7
  v_lshlrev_b32 v11, 7, v11
  v_bfe_u32 v7, v2, 3, 1
  v_lshl_add_u32 v11, v7, 6, v11
  v_and_b32 v7, 3, v5
  v_lshl_add_u32 v11, v7, 3, v11
  v_bfe_u32 v7, v2, 4, 1
  v_lshl_add_u32 v11, v7, 5, v11
  s_mul_i32 s22, s17, 6144
  s_add_u32 s22, s22, 133120
  v_add_u32 v11, s22, v11
  v_xor_b32 v10, 64, v11
  v_add_u32 v14, 88064, v3
  s_mul_i32 s23, s19, 176128
  s_mul_i32 s40, s17, 360448
  s_mul_i32 s41, s17, 22528
  s_add_u32 s41, s41, s23
  s_add_u32 s30, s40, 360448
  s_min_u32 s30, s30, 1409024
  v_mov_b32 v64, 0
  v_mov_b32 v65, 0
  v_mov_b32 v66, 0
  v_mov_b32 v67, 0
  v_mov_b32 v68, 0
  v_mov_b32 v69, 0
  v_mov_b32 v70, 0
  v_mov_b32 v71, 0
  v_mov_b32 v72, 0
  v_mov_b32 v73, 0
  v_mov_b32 v74, 0
  v_mov_b32 v75, 0
  v_mov_b32 v76, 0
  v_mov_b32 v77, 0
  v_mov_b32 v78, 0
  v_mov_b32 v79, 0
  v_mov_b32 v80, 0
  v_mov_b32 v81, 0
  v_mov_b32 v82, 0
  v_mov_b32 v83, 0
  v_mov_b32 v84, 0
  v_mov_b32 v85, 0
  v_mov_b32 v86, 0
  v_mov_b32 v87, 0
  v_mov_b32 v88, 0
  v_mov_b32 v89, 0
  v_mov_b32 v90, 0
  v_mov_b32 v91, 0
  v_mov_b32 v92, 0
  v_mov_b32 v93, 0
  v_mov_b32 v94, 0
  v_mov_b32 v95, 0
  v_mov_b32 v96, 0
  v_mov_b32 v97, 0
  v_mov_b32 v98, 0
  v_mov_b32 v99, 0
  v_mov_b32 v100, 0
  v_mov_b32 v101, 0
  v_mov_b32 v102, 0
  v_mov_b32 v103, 0
  v_mov_b32 v104, 0
  v_mov_b32 v105, 0
  v_mov_b32 v106, 0
  v_mov_b32 v107, 0
  v_mov_b32 v108, 0
  v_mov_b32 v109, 0
  v_mov_b32 v110, 0
  v_mov_b32 v111, 0
  v_mov_b32 v112, 0
  v_mov_b32 v113, 0
  v_mov_b32 v114, 0
  v_mov_b32 v115, 0
  v_mov_b32 v116, 0
  v_mov_b32 v117, 0
  v_mov_b32 v118, 0
  v_mov_b32 v119, 0
  v_mov_b32 v120, 0
  v_mov_b32 v121, 0
  v_mov_b32 v122, 0
  v_mov_b32 v123, 0
  v_mov_b32 v124, 0
  v_mov_b32 v125, 0
  v_mov_b32 v126, 0
  v_mov_b32 v127, 0
  s_add_u32 m0, s22, 0
  s_nop 0
  buffer_load_dwordx4 v12, s[28:31], s40 offen lds
  s_add_u32 m0, s22, 1024
  s_nop 0
  buffer_load_dwordx4 v13, s[28:31], s40 offen lds
  buffer_load_dwordx4 v[16:19], v3, s[32:35], s41 offen
  buffer_load_dwordx4 v[20:23], v14, s[32:35], s41 offen
  s_add_u32 s40, s40, 16384
  s_add_u32 s41, s41, 1024
  s_add_u32 m0, s22, 2048
  s_nop 0
  buffer_load_dwordx4 v12, s[28:31], s40 offen lds
  s_add_u32 m0, s22, 3072
  s_nop 0
  buffer_load_dwordx4 v13, s[28:31], s40 offen lds
  buffer_load_dwordx4 v[24:27], v3, s[32:35], s41 offen
  buffer_load_dwordx4 v[28:31], v14, s[32:35], s41 offen
  s_add_u32 s40, s40, 16384
  s_add_u32 s41, s41, 1024
  s_barrier
  s_barrier
  s_setprio 0
  s_waitcnt vmcnt(4)
  ds_read_b64_tr_b16 v[40:41], v11 offset:0
  ds_read_b64_tr_b16 v[42:43], v11 offset:512
  ds_read_b64_tr_b16 v[44:45], v10 offset:0
  ds_read_b64_tr_b16 v[46:47], v10 offset:512
  s_mov_b32 s42, 0
K2_DL:
  s_add_u32 m0, s22, 4096
  s_nop 0
  buffer_load_dwordx4 v12, s[28:31], s40 offen lds
  s_add_u32 m0, s22, 5120
  s_nop 0
  buffer_load_dwordx4 v13, s[28:31], s40 offen lds
  buffer_load_dwordx4 v[32:35], v3, s[32:35], s41 offen
  buffer_load_dwordx4 v[36:39], v14, s[32:35], s41 offen
  s_add_u32 s40, s40, 16384
  s_add_u32 s41, s41, 1024
  s_waitcnt vmcnt(4) lgkmcnt(0)
  ds_read_b64_tr_b16 v[48:49], v11 offset:2048
  ds_read_b64_tr_b16 v[50:51], v11 offset:2560
  ds_read_b64_tr_b16 v[52:53], v10 offset:2048
  ds_read_b64_tr_b16 v[54:55], v10 offset:2560
  v_mfma_f32_32x32x16_bf16 v[64:79], v[40:43], v[16:19], v[64:79]
  v_mfma_f32_32x32x16_bf16 v[80:95], v[44:47], v[16:19], v[80:95]
  v_mfma_f32_32x32x16_bf16 v[96:111], v[40:43], v[20:23], v[96:111]
  v_mfma_f32_32x32x16_bf16 v[112:127], v[44:47], v[20:23], v[112:127]
  s_add_u32 m0, s22, 0
  s_nop 0
  buffer_load_dwordx4 v12, s[28:31], s40 offen lds
  s_add_u32 m0, s22, 1024
  s_nop 0
  buffer_load_dwordx4 v13, s[28:31], s40 offen lds
  buffer_load_dwordx4 v[16:19], v3, s[32:35], s41 offen
  buffer_load_dwordx4 v[20:23], v14, s[32:35], s41 offen
  s_add_u32 s40, s40, 16384
  s_add_u32 s41, s41, 1024
  s_waitcnt vmcnt(4) lgkmcnt(0)
  ds_read_b64_tr_b16 v[40:41], v11 offset:4096
  ds_read_b64_tr_b16 v[42:43], v11 offset:4608
  ds_read_b64_tr_b16 v[44:45], v10 offset:4096
  ds_read_b64_tr_b16 v[46:47], v10 offset:4608
  v_mfma_f32_32x32x16_bf16 v[64:79], v[48:51], v[24:27], v[64:79]
  v_mfma_f32_32x32x16_bf16 v[80:95], v[52:55], v[24:27], v[80:95]
  v_mfma_f32_32x32x16_bf16 v[96:111], v[48:51], v[28:31], v[96:111]
  v_mfma_f32_32x32x16_bf16 v[112:127], v[52:55], v[28:31], v[112:127]
  s_add_u32 m0, s22, 2048
  s_nop 0
  buffer_load_dwordx4 v12, s[28:31], s40 offen lds
  s_add_u32 m0, s22, 3072
  s_nop 0
  buffer_load_dwordx4 v13, s[28:31], s40 offen lds
  buffer_load_dwordx4 v[24:27], v3, s[32:35], s41 offen
  buffer_load_dwordx4 v[28:31], v14, s[32:35], s41 offen
  s_add_u32 s40, s40, 16384
  s_add_u32 s41, s41, 1024
  s_waitcnt vmcnt(4) lgkmcnt(0)
  ds_read_b64_tr_b16 v[48:49], v11 offset:0
  ds_read_b64_tr_b16 v[50:51], v11 offset:512
  ds_read_b64_tr_b16 v[52:53], v10 offset:0
  ds_read_b64_tr_b16 v[54:55], v10 offset:512
  v_mfma_f32_32x32x16_bf16 v[64:79], v[40:43], v[32:35], v[64:79]
  v_mfma_f32_32x32x16_bf16 v[80:95], v[44:47], v[32:35], v[80:95]
  v_mfma_f32_32x32x16_bf16 v[96:111], v[40:43], v[36:39], v[96:111]
  v_mfma_f32_32x32x16_bf16 v[112:127], v[44:47], v[36:39], v[112:127]
  s_add_u32 m0, s22, 4096
  s_nop 0
  buffer_load_dwordx4 v12, s[28:31], s40 offen lds
  s_add_u32 m0, s22, 5120
  s_nop 0
  buffer_load_dwordx4 v13, s[28:31], s40 offen lds
  buffer_load_dwordx4 v[32:35], v3, s[32:35], s41 offen
  buffer_load_dwordx4 v[36:39], v14, s[32:35], s41 offen
  s_add_u32 s40, s40, 16384
  s_add_u32 s41, s41, 1024
  s_waitcnt vmcnt(4) lgkmcnt(0)
  ds_read_b64_tr_b16 v[40:41], v11 offset:2048
  ds_read_b64_tr_b16 v[42:43], v11 offset:2560
  ds_read_b64_tr_b16 v[44:45], v10 offset:2048
  ds_read_b64_tr_b16 v[46:47], v10 offset:2560
  v_mfma_f32_32x32x16_bf16 v[64:79], v[48:51], v[16:19], v[64:79]
  v_mfma_f32_32x32x16_bf16 v[80:95], v[52:55], v[16:19], v[80:95]
  v_mfma_f32_32x32x16_bf16 v[96:111], v[48:51], v[20:23], v[96:111]
  v_mfma_f32_32x32x16_bf16 v[112:127], v[52:55], v[20:23], v[112:127]
  s_add_u32 m0, s22, 0
  s_nop 0
  buffer_load_dwordx4 v12, s[28:31], s40 offen lds
  s_add_u32 m0, s22, 1024
  s_nop 0
  buffer_load_dwordx4 v13, s[28:31], s40 offen lds
  buffer_load_dwordx4 v[16:19], v3, s[32:35], s41 offen
  buffer_load_dwordx4 v[20:23], v14, s[32:35], s41 offen
  s_add_u32 s40, s40, 16384
  s_add_u32 s41, s41, 1024
  s_waitcnt vmcnt(4) lgkmcnt(0)
  ds_read_b64_tr_b16 v[48:49], v11 offset:4096
  ds_read_b64_tr_b16 v[50:51], v11 offset:4608
  ds_read_b64_tr_b16 v[52:53], v10 offset:4096
  ds_read_b64_tr_b16 v[54:55], v10 offset:4608
  v_mfma_f32_32x32x16_bf16 v[64:79], v[40:43], v[24:27], v[64:79]
  v_mfma_f32_32x32x16_bf16 v[80:95], v[44:47], v[24:27], v[80:95]
  v_mfma_f32_32x32x16_bf16 v[96:111], v[40:43], v[28:31], v[96:111]
  v_mfma_f32_32x32x16_bf16 v[112:127], v[44:47], v[28:31], v[112:127]
  s_add_u32 m0, s22, 2048
  s_nop 0
  buffer_load_dwordx4 v12, s[28:31], s40 offen lds
  s_add_u32 m0, s22, 3072
  s_nop 0
  buffer_load_dwordx4 v13, s[28:31], s40 offen lds
  buffer_load_dwordx4 v[24:27], v3, s[32:35], s41 offen
  buffer_load_dwordx4 v[28:31], v14, s[32:35], s41 offen
  s_add_u32 s40, s40, 16384
  s_add_u32 s41, s41, 1024
  s_waitcnt vmcnt(4) lgkmcnt(0)
  ds_read_b64_tr_b16 v[40:41], v11 offset:0
  ds_read_b64_tr_b16 v[42:43], v11 offset:512
  ds_read_b64_tr_b16 v[44:45], v10 offset:0
  ds_read_b64_tr_b16 v[46:47], v10 offset:512
  v_mfma_f32_32x32x16_bf16 v[64:79], v[48:51], v[32:35], v[64:79]
  v_mfma_f32_32x32x16_bf16 v[80:95], v[52:55], v[32:35], v[80:95]
  v_mfma_f32_32x32x16_bf16 v[96:111], v[48:51], v[36:39], v[96:111]
  v_mfma_f32_32x32x16_bf16 v[112:127], v[52:55], v[36:39], v[112:127]
  s_add_u32 s42, s42, 6
  s_cmp_lt_u32 s42, 22
  s_cbranch_scc1 K2_DL
  s_cmp_lg_u32 s17, 0
  s_cbranch_scc1 K2_DST
  v_and_b32 v4, 31, v2
  v_lshrrev_b32 v5, 5, v2
  s_lshl_b32 s48, s19, 6
  v_add_u32 v6, s48, v4
  v_lshlrev_b32 v6, 10, v6
  v_lshl_add_u32 v6, v5, 3, v6
  v_add_u32 v6, s21, v6
  s_mov_b32 s49, 0
  buffer_load_dwordx2 v[16:17], v6, s[36:39], s49 offen offset:0
  buffer_load_dwordx2 v[18:19], v6, s[36:39], s49 offen offset:16
  buffer_load_dwordx2 v[20:21], v6, s[36:39], s49 offen offset:32
  buffer_load_dwordx2 v[22:23], v6, s[36:39], s49 offen offset:48
  buffer_load_dwordx2 v[24:25], v6, s[36:39], s49 offen offset:64
  buffer_load_dwordx2 v[26:27], v6, s[36:39], s49 offen offset:80
  buffer_load_dwordx2 v[28:29], v6, s[36:39], s49 offen offset:96
  buffer_load_dwordx2 v[30:31], v6, s[36:39], s49 offen offset:112
  s_waitcnt vmcnt(0)
  v_lshlrev_b32 v44, 16, v16
  v_and_b32 v45, 0xffff0000, v16
  v_add_f32 v64, v64, v44
  v_add_f32 v65, v65, v45
  v_lshlrev_b32 v44, 16, v17
  v_and_b32 v45, 0xffff0000, v17
  v_add_f32 v66, v66, v44
  v_add_f32 v67, v67, v45
  v_lshlrev_b32 v44, 16, v18
  v_and_b32 v45, 0xffff0000, v18
  v_add_f32 v68, v68, v44
  v_add_f32 v69, v69, v45
  v_lshlrev_b32 v44, 16, v19
  v_and_b32 v45, 0xffff0000, v19
  v_add_f32 v70, v70, v44
  v_add_f32 v71, v71, v45
  v_lshlrev_b32 v44, 16, v20
  v_and_b32 v45, 0xffff0000, v20
  v_add_f32 v72, v72, v44
  v_add_f32 v73, v73, v45
  v_lshlrev_b32 v44, 16, v21
  v_and_b32 v45, 0xffff0000, v21
  v_add_f32 v74, v74, v44
  v_add_f32 v75, v75, v45
  v_lshlrev_b32 v44, 16, v22
  v_and_b32 v45, 0xffff0000, v22
  v_add_f32 v76, v76, v44
  v_add_f32 v77, v77, v45
  v_lshlrev_b32 v44, 16, v23
  v_and_b32 v45, 0xffff0000, v23
  v_add_f32 v78, v78, v44
  v_add_f32 v79, v79, v45
  v_lshlrev_b32 v44, 16, v24
  v_and_b32 v45, 0xffff0000, v24
  v_add_f32 v80, v80, v44
  v_add_f32 v81, v81, v45
  v_lshlrev_b32 v44, 16, v25
  v_and_b32 v45, 0xffff0000, v25
  v_add_f32 v82, v82, v44
  v_add_f32 v83, v83, v45
  v_lshlrev_b32 v44, 16, v26
  v_and_b32 v45, 0xffff0000, v26
  v_add_f32 v84, v84, v44
  v_add_f32 v85, v85, v45
  v_lshlrev_b32 v44, 16, v27
  v_and_b32 v45, 0xffff0000, v27
  v_add_f32 v86, v86, v44
  v_add_f32 v87, v87, v45
  v_lshlrev_b32 v44, 16, v28
  v_and_b32 v45, 0xffff0000, v28
  v_add_f32 v88, v88, v44
  v_add_f32 v89, v89, v45
  v_lshlrev_b32 v44, 16, v29
  v_and_b32 v45, 0xffff0000, v29
  v_add_f32 v90, v90, v44
  v_add_f32 v91, v91, v45
  v_lshlrev_b32 v44, 16, v30
  v_and_b32 v45, 0xffff0000, v30
  v_add_f32 v92, v92, v44
  v_add_f32 v93, v93, v45
  v_lshlrev_b32 v44, 16, v31
  v_and_b32 v45, 0xffff0000, v31
  v_add_f32 v94, v94, v44
  v_add_f32 v95, v95, v45
  s_mov_b32 s49, 32768
  buffer_load_dwordx2 v[16:17], v6, s[36:39], s49 offen offset:0
  buffer_load_dwordx2 v[18:19], v6, s[36:39], s49 offen offset:16
  buffer_load_dwordx2 v[20:21], v6, s[36:39], s49 offen offset:32
  buffer_load_dwordx2 v[22:23], v6, s[36:39], s49 offen offset:48
  buffer_load_dwordx2 v[24:25], v6, s[36:39], s49 offen offset:64
  buffer_load_dwordx2 v[26:27], v6, s[36:39], s49 offen offset:80
  buffer_load_dwordx2 v[28:29], v6, s[36:39], s49 offen offset:96
  buffer_load_dwordx2 v[30:31], v6, s[36:39], s49 offen offset:112
  s_waitcnt vmcnt(0)
  v_lshlrev_b32 v44, 16, v16
  v_and_b32 v45, 0xffff0000, v16
  v_add_f32 v96, v96, v44
  v_add_f32 v97, v97, v45
  v_lshlrev_b32 v44, 16, v17
  v_and_b32 v45, 0xffff0000, v17
  v_add_f32 v98, v98, v44
  v_add_f32 v99, v99, v45
  v_lshlrev_b32 v44, 16, v18
  v_and_b32 v45, 0xffff0000, v18
  v_add_f32 v100, v100, v44
  v_add_f32 v101, v101, v45
  v_lshlrev_b32 v44, 16, v19
  v_and_b32 v45, 0xffff0000, v19
  v_add_f32 v102, v102, v44
  v_add_f32 v103, v103, v45
  v_lshlrev_b32 v44, 16, v20
  v_and_b32 v45, 0xffff0000, v20
  v_add_f32 v104, v104, v44
  v_add_f32 v105, v105, v45
  v_lshlrev_b32 v44, 16, v21
  v_and_b32 v45, 0xffff0000, v21
  v_add_f32 v106, v106, v44
  v_add_f32 v107, v107, v45
  v_lshlrev_b32 v44, 16, v22
  v_and_b32 v45, 0xffff0000, v22
  v_add_f32 v108, v108, v44
  v_add_f32 v109, v109, v45
  v_lshlrev_b32 v44, 16, v23
  v_and_b32 v45, 0xffff0000, v23
  v_add_f32 v110, v110, v44
  v_add_f32 v111, v111, v45
  v_lshlrev_b32 v44, 16, v24
  v_and_b32 v45, 0xffff0000, v24
  v_add_f32 v112, v112, v44
  v_add_f32 v113, v113, v45
  v_lshlrev_b32 v44, 16, v25
  v_and_b32 v45, 0xffff0000, v25
  v_add_f32 v114, v114, v44
  v_add_f32 v115, v115, v45
  v_lshlrev_b32 v44, 16, v26
  v_and_b32 v45, 0xffff0000, v26
  v_add_f32 v116, v116, v44
  v_add_f32 v117, v117, v45
  v_lshlrev_b32 v44, 16, v27
  v_and_b32 v45, 0xffff0000, v27
  v_add_f32 v118, v118, v44
  v_add_f32 v119, v119, v45
  v_lshlrev_b32 v44, 16, v28
  v_and_b32 v45, 0xffff0000, v28
  v_add_f32 v120, v120, v44
  v_add_f32 v121, v121, v45
  v_lshlrev_b32 v44, 16, v29
  v_and_b32 v45, 0xffff0000, v29
  v_add_f32 v122, v122, v44
  v_add_f32 v123, v123, v45
  v_lshlrev_b32 v44, 16, v30
  v_and_b32 v45, 0xffff0000, v30
  v_add_f32 v124, v124, v44
  v_add_f32 v125, v125, v45
  v_lshlrev_b32 v44, 16, v31
  v_and_b32 v45, 0xffff0000, v31
  v_add_f32 v126, v126, v44
  v_add_f32 v127, v127, v45
K2_DST:
  s_lshl_b32 s23, s19, 16
  s_lshl_b32 s48, s20, 12
  s_add_u32 s23, s23, s48
  s_lshl_b32 s48, s17, 21
  s_add_u32 s23, s23, s48
  s_add_u32 s23, s23, 16777216
  v_cvt_pk_bf16_f32 v16, v64, v65
  v_cvt_pk_bf16_f32 v17, v66, v67
  v_cvt_pk_bf16_f32 v18, v68, v69
  v_cvt_pk_bf16_f32 v19, v70, v71
  v_cvt_pk_bf16_f32 v20, v72, v73
  v_cvt_pk_bf16_f32 v21, v74, v75
  v_cvt_pk_bf16_f32 v22, v76, v77
  v_cvt_pk_bf16_f32 v23, v78, v79
  buffer_store_dwordx4 v[16:19], v3, s[24:27], s23 offen sc0 sc1
  buffer_store_dwordx4 v[20:23], v3, s[24:27], s23 offen offset:1024 sc0 sc1
  s_add_u32 s23, s23, 2048
  v_cvt_pk_bf16_f32 v16, v80, v81
  v_cvt_pk_bf16_f32 v17, v82, v83
  v_cvt_pk_bf16_f32 v18, v84, v85
  v_cvt_pk_bf16_f32 v19, v86, v87
  v_cvt_pk_bf16_f32 v20, v88, v89
  v_cvt_pk_bf16_f32 v21, v90, v91
  v_cvt_pk_bf16_f32 v22, v92, v93
  v_cvt_pk_bf16_f32 v23, v94, v95
  buffer_store_dwordx4 v[16:19], v3, s[24:27], s23 offen sc0 sc1
  buffer_store_dwordx4 v[20:23], v3, s[24:27], s23 offen offset:1024 sc0 sc1
  s_add_u32 s23, s23, 30720
  v_cvt_pk_bf16_f32 v16, v96, v97
  v_cvt_pk_bf16_f32 v17, v98, v99
  v_cvt_pk_bf16_f32 v18, v100, v101
  v_cvt_pk_bf16_f32 v19, v102, v103
  v_cvt_pk_bf16_f32 v20, v104, v105
  v_cvt_pk_bf16_f32 v21, v106, v107
  v_cvt_pk_bf16_f32 v22, v108, v109
  v_cvt_pk_bf16_f32 v23, v110, v111
  buffer_store_dwordx4 v[16:19], v3, s[24:27], s23 offen sc0 sc1
  buffer_store_dwordx4 v[20:23], v3, s[24:27], s23 offen offset:1024 sc0 sc1
  s_add_u32 s23, s23, 2048
  v_cvt_pk_bf16_f32 v16, v112, v113
  v_cvt_pk_bf16_f32 v17, v114, v115
  v_cvt_pk_bf16_f32 v18, v116, v117
  v_cvt_pk_bf16_f32 v19, v118, v119
  v_cvt_pk_bf16_f32 v20, v120, v121
  v_cvt_pk_bf16_f32 v21, v122, v123
  v_cvt_pk_bf16_f32 v22, v124, v125
  v_cvt_pk_bf16_f32 v23, v126, v127
  buffer_store_dwordx4 v[16:19], v3, s[24:27], s23 offen sc0 sc1
  buffer_store_dwordx4 v[20:23], v3, s[24:27], s23 offen offset:1024 sc0 sc1
  s_add_u32 s23, s23, 30720
K2_END:
  s_endpgm
.globl k3_kernel
.p2align 8
.type k3_kernel,@function
k3_kernel:
  s_cmp_ge_u32 s2, 256
  s_cbranch_scc1 K3_END
  s_load_dwordx2 s[6:7], s[0:1], 16
  s_load_dwordx2 s[10:11], s[0:1], 56
  s_load_dwordx2 s[12:13], s[0:1], 72
  v_lshrrev_b32 v1, 6, v0
  s_nop 0
  v_readfirstlane_b32 s16, v1
  v_and_b32 v2, 63, v0
  s_and_b32 s14, s2, 7
  s_lshl_b32 s14, s14, 2
  s_bfe_u32 s15, s2, 0x20003
  s_add_u32 s14, s14, s15
  s_lshr_b32 s15, s2, 5
  s_lshr_b32 s17, s16, 1
  s_and_b32 s18, s16, 1
  s_waitcnt lgkmcnt(0)
  s_mov_b32 s32, s10
  s_and_b32 s33, s11, 0xffff
  s_mov_b32 s34, 2097152
  s_mov_b32 s35, 0x20000
  s_mov_b32 s24, s12
  s_and_b32 s25, s13, 0xffff
  s_mov_b32 s26, 268435456
  s_mov_b32 s27, 0x20000
  s_mov_b32 s28, s6
  s_and_b32 s29, s7, 0xffff
  s_mov_b32 s30, 524288
  s_mov_b32 s31, 0x20000
  v_lshlrev_b32 v3, 4, v2
  s_lshl_b32 s19, s14, 1
  s_add_u32 s19, s19, s17
  s_lshl_b32 s21, s19, 4
  s_lshl_b32 s22, s15, 1
  s_add_u32 s22, s22, s18
  s_add_u32 s21, s21, s22
  s_lshl_b32 s21, s21, 11
  s_add_u32 s21, s21, 16777216
  buffer_load_dwordx4 v[80:83], v3, s[24:27], s21 offen
  buffer_load_dwordx4 v[84:87], v3, s[24:27], s21 offen offset:1024
  s_add_u32 s21, s21, 2097152
  buffer_load_dwordx4 v[88:91], v3, s[24:27], s21 offen
  buffer_load_dwordx4 v[92:95], v3, s[24:27], s21 offen offset:1024
  s_add_u32 s21, s21, 2097152
  buffer_load_dwordx4 v[96:99], v3, s[24:27], s21 offen
  buffer_load_dwordx4 v[100:103], v3, s[24:27], s21 offen offset:1024
  s_add_u32 s21, s21, 2097152
  buffer_load_dwordx4 v[104:107], v3, s[24:27], s21 offen
  buffer_load_dwordx4 v[108:111], v3, s[24:27], s21 offen offset:1024
  s_add_u32 s21, s21, 2097152
  s_lshl_b32 s23, s19, 15
  s_lshl_b32 s40, s18, 14
  s_add_u32 s23, s23, s40
  s_add_u32 s23, s23, 12582912
  s_lshl_b32 s41, s16, 14
  v_lshrrev_b32 v7, 2, v2
  v_and_b32 v12, 3, v7
  v_bfe_u32 v8, v7, 3, 1
  v_lshl_add_u32 v12, v8, 2, v12
  v_bfe_u32 v8, v7, 2, 1
  v_lshl_add_u32 v12, v8, 3, v12
  v_lshlrev_b32 v12, 10, v12
  v_and_b32 v8, 3, v2
  v_lshl_add_u32 v12, v8, 4, v12
  s_lshl_b32 s42, s22, 6
  v_add_u32 v12, s42, v12
  s_lshl_b32 s43, s17, 18
  s_lshl_b32 s44, s18, 15
  s_lshl_b32 s45, s17, 14
  s_add_u32 s44, s44, s45
  s_add_u32 s44, s44, 65536
  s_mov_b32 s46, 0
K3_DMA:
  s_mov_b32 m0, s41
  s_nop 0
  buffer_load_dwordx4 v3, s[24:27], s23 offen lds
  s_mov_b32 m0, s44
  s_nop 0
  buffer_load_dwordx4 v12, s[28:31], s43 offen lds
  s_add_u32 s23, s23, 1024
  s_add_u32 s41, s41, 1024
  s_add_u32 s43, s43, 16384
  s_add_u32 s44, s44, 1024
  s_add_u32 s46, s46, 1
  s_cmp_lt_u32 s46, 16
  s_cbranch_scc1 K3_DMA
  s_lshl_b32 s47, s17, 15
  v_add_u32 v10, s47, v3
  v_and_b32 v7, 15, v2
  v_lshrrev_b32 v11, 2, v7
  v_lshrrev_b32 v8, 5, v2
  v_lshl_add_u32 v11, v8, 3, v11
  v_lshlrev_b32 v11, 6, v11
  v_and_b32 v7, 3, v7
  v_lshlrev_b32 v7, 3, v7
  v_bfe_u32 v8, v2, 4, 1
  v_lshl_add_u32 v7, v8, 5, v7
  v_add_u32 v11, v11, v7
  s_lshl_b32 s47, s18, 15
  s_add_u32 s47, s47, 65536
  v_add_u32 v11, s47, v11
  s_waitcnt vmcnt(0)
  v_lshlrev_b32 v64, 16, v80
  v_and_b32 v65, 0xffff0000, v80
  v_lshlrev_b32 v40, 16, v88
  v_and_b32 v41, 0xffff0000, v88
  v_add_f32 v64, v64, v40
  v_add_f32 v65, v65, v41
  v_lshlrev_b32 v40, 16, v96
  v_and_b32 v41, 0xffff0000, v96
  v_add_f32 v64, v64, v40
  v_add_f32 v65, v65, v41
  v_lshlrev_b32 v40, 16, v104
  v_and_b32 v41, 0xffff0000, v104
  v_add_f32 v64, v64, v40
  v_add_f32 v65, v65, v41
  v_lshlrev_b32 v66, 16, v81
  v_and_b32 v67, 0xffff0000, v81
  v_lshlrev_b32 v40, 16, v89
  v_and_b32 v41, 0xffff0000, v89
  v_add_f32 v66, v66, v40
  v_add_f32 v67, v67, v41
  v_lshlrev_b32 v40, 16, v97
  v_and_b32 v41, 0xffff0000, v97
  v_add_f32 v66, v66, v40
  v_add_f32 v67, v67, v41
  v_lshlrev_b32 v40, 16, v105
  v_and_b32 v41, 0xffff0000, v105
  v_add_f32 v66, v66, v40
  v_add_f32 v67, v67, v41
  v_lshlrev_b32 v68, 16, v82
  v_and_b32 v69, 0xffff0000, v82
  v_lshlrev_b32 v40, 16, v90
  v_and_b32 v41, 0xffff0000, v90
  v_add_f32 v68, v68, v40
  v_add_f32 v69, v69, v41
  v_lshlrev_b32 v40, 16, v98
  v_and_b32 v41, 0xffff0000, v98
  v_add_f32 v68, v68, v40
  v_add_f32 v69, v69, v41
  v_lshlrev_b32 v40, 16, v106
  v_and_b32 v41, 0xffff0000, v106
  v_add_f32 v68, v68, v40
  v_add_f32 v69, v69, v41
  v_lshlrev_b32 v70, 16, v83
  v_and_b32 v71, 0xffff0000, v83
  v_lshlrev_b32 v40, 16, v91
  v_and_b32 v41, 0xffff0000, v91
  v_add_f32 v70, v70, v40
  v_add_f32 v71, v71, v41
  v_lshlrev_b32 v40, 16, v99
  v_and_b32 v41, 0xffff0000, v99
  v_add_f32 v70, v70, v40
  v_add_f32 v71, v71, v41
  v_lshlrev_b32 v40, 16, v107
  v_and_b32 v41, 0xffff0000, v107
  v_add_f32 v70, v70, v40
  v_add_f32 v71, v71, v41
  v_lshlrev_b32 v72, 16, v84
  v_and_b32 v73, 0xffff0000, v84
  v_lshlrev_b32 v40, 16, v92
  v_and_b32 v41, 0xffff0000, v92
  v_add_f32 v72, v72, v40
  v_add_f32 v73, v73, v41
  v_lshlrev_b32 v40, 16, v100
  v_and_b32 v41, 0xffff0000, v100
  v_add_f32 v72, v72, v40
  v_add_f32 v73, v73, v41
  v_lshlrev_b32 v40, 16, v108
  v_and_b32 v41, 0xffff0000, v108
  v_add_f32 v72, v72, v40
  v_add_f32 v73, v73, v41
  v_lshlrev_b32 v74, 16, v85
  v_and_b32 v75, 0xffff0000, v85
  v_lshlrev_b32 v40, 16, v93
  v_and_b32 v41, 0xffff0000, v93
  v_add_f32 v74, v74, v40
  v_add_f32 v75, v75, v41
  v_lshlrev_b32 v40, 16, v101
  v_and_b32 v41, 0xffff0000, v101
  v_add_f32 v74, v74, v40
  v_add_f32 v75, v75, v41
  v_lshlrev_b32 v40, 16, v109
  v_and_b32 v41, 0xffff0000, v109
  v_add_f32 v74, v74, v40
  v_add_f32 v75, v75, v41
  v_lshlrev_b32 v76, 16, v86
  v_and_b32 v77, 0xffff0000, v86
  v_lshlrev_b32 v40, 16, v94
  v_and_b32 v41, 0xffff0000, v94
  v_add_f32 v76, v76, v40
  v_add_f32 v77, v77, v41
  v_lshlrev_b32 v40, 16, v102
  v_and_b32 v41, 0xffff0000, v102
  v_add_f32 v76, v76, v40
  v_add_f32 v77, v77, v41
  v_lshlrev_b32 v40, 16, v110
  v_and_b32 v41, 0xffff0000, v110
  v_add_f32 v76, v76, v40
  v_add_f32 v77, v77, v41
  v_lshlrev_b32 v78, 16, v87
  v_and_b32 v79, 0xffff0000, v87
  v_lshlrev_b32 v40, 16, v95
  v_and_b32 v41, 0xffff0000, v95
  v_add_f32 v78, v78, v40
  v_add_f32 v79, v79, v41
  v_lshlrev_b32 v40, 16, v103
  v_and_b32 v41, 0xffff0000, v103
  v_add_f32 v78, v78, v40
  v_add_f32 v79, v79, v41
  v_lshlrev_b32 v40, 16, v111
  v_and_b32 v41, 0xffff0000, v111
  v_add_f32 v78, v78, v40
  v_add_f32 v79, v79, v41
  s_barrier
  ds_read_b128 v[16:19], v10 offset:0
  ds_read_b64_tr_b16 v[20:21], v11 offset:0
  ds_read_b64_tr_b16 v[22:23], v11 offset:256
  s_mov_b32 s46, 0
K3_L:
  ds_read_b128 v[24:27], v10 offset:1024
  ds_read_b64_tr_b16 v[28:29], v11 offset:1024
  ds_read_b64_tr_b16 v[30:31], v11 offset:1280
  s_waitcnt lgkmcnt(3)
  v_mfma_f32_32x32x16_bf16 v[64:79], v[20:23], v[16:19], v[64:79]
  ds_read_b128 v[16:19], v10 offset:2048
  ds_read_b64_tr_b16 v[20:21], v11 offset:2048
  ds_read_b64_tr_b16 v[22:23], v11 offset:2304
  s_waitcnt lgkmcnt(3)
  v_mfma_f32_32x32x16_bf16 v[64:79], v[28:31], v[24:27], v[64:79]
  ds_read_b128 v[24:27], v10 offset:3072
  ds_read_b64_tr_b16 v[28:29], v11 offset:3072
  ds_read_b64_tr_b16 v[30:31], v11 offset:3328
  s_waitcnt lgkmcnt(3)
  v_mfma_f32_32x32x16_bf16 v[64:79], v[20:23], v[16:19], v[64:79]
  ds_read_b128 v[16:19], v10 offset:4096
  ds_read_b64_tr_b16 v[20:21], v11 offset:4096
  ds_read_b64_tr_b16 v[22:23], v11 offset:4352
  s_waitcnt lgkmcnt(3)
  v_mfma_f32_32x32x16_bf16 v[64:79], v[28:31], v[24:27], v[64:79]
  v_add_u32 v10, 4096, v10
  v_add_u32 v11, 4096, v11
  s_add_u32 s46, s46, 4
  s_cmp_lt_u32 s46, 32
  s_cbranch_scc1 K3_L
  v_and_b32 v4, 31, v2
  v_lshrrev_b32 v5, 5, v2
  s_lshl_b32 s47, s19, 5
  v_add_u32 v6, s47, v4
  v_lshlrev_b32 v6, 10, v6
  v_lshl_add_u32 v6, v5, 3, v6
  v_add_u32 v6, s42, v6
  v_cvt_pk_bf16_f32 v32, v64, v65
  v_cvt_pk_bf16_f32 v33, v66, v67
  buffer_store_dwordx2 v[32:33], v6, s[32:35], 0 offen offset:0
  v_cvt_pk_bf16_f32 v34, v68, v69
  v_cvt_pk_bf16_f32 v35, v70, v71
  buffer_store_dwordx2 v[34:35], v6, s[32:35], 0 offen offset:16
  v_cvt_pk_bf16_f32 v36, v72, v73
  v_cvt_pk_bf16_f32 v37, v74, v75
  buffer_store_dwordx2 v[36:37], v6, s[32:35], 0 offen offset:32
  v_cvt_pk_bf16_f32 v38, v76, v77
  v_cvt_pk_bf16_f32 v39, v78, v79
  buffer_store_dwordx2 v[38:39], v6, s[32:35], 0 offen offset:48
K3_END:
  s_endpgm
.section .rodata,"a"
.p2align 6
.amdhsa_kernel k0_kernel
  .amdhsa_next_free_vgpr 80
  .amdhsa_next_free_sgpr 102
  .amdhsa_accum_offset 80
  .amdhsa_group_segment_fixed_size 0
  .amdhsa_kernarg_size 80
  .amdhsa_user_sgpr_count 2
  .amdhsa_user_sgpr_kernarg_segment_ptr 1
  .amdhsa_system_sgpr_workgroup_id_x 1
.end_amdhsa_kernel
.p2align 6
.amdhsa_kernel k1_kernel
  .amdhsa_next_free_vgpr 128
  .amdhsa_next_free_sgpr 102
  .amdhsa_accum_offset 128
  .amdhsa_group_segment_fixed_size 0
  .amdhsa_kernarg_size 80
  .amdhsa_user_sgpr_count 2
  .amdhsa_user_sgpr_kernarg_segment_ptr 1
  .amdhsa_system_sgpr_workgroup_id_x 1
.end_amdhsa_kernel
.p2align 6
.amdhsa_kernel k2_kernel
  .amdhsa_next_free_vgpr 128
  .amdhsa_next_free_sgpr 102
  .amdhsa_accum_offset 128
  .amdhsa_group_segment_fixed_size 0
  .amdhsa_kernarg_size 80
  .amdhsa_user_sgpr_count 2
  .amdhsa_user_sgpr_kernarg_segment_ptr 1
  .amdhsa_system_sgpr_workgroup_id_x 1
.end_amdhsa_kernel
.p2align 6
.amdhsa_kernel k3_kernel
  .amdhsa_next_free_vgpr 128
  .amdhsa_next_free_sgpr 102
  .amdhsa_accum_offset 128
  .amdhsa_group_segment_fixed_size 0
  .amdhsa_kernarg_size 80
  .amdhsa_user_sgpr_count 2
  .amdhsa_user_sgpr_kernarg_segment_ptr 1
  .amdhsa_system_sgpr_workgroup_id_x 1
.end_amdhsa_kernel
```
